```python
import torch

def _softmax(x, axis=-1):
    return torch.softmax(x, dim=axis)
def _gelu(x):
    return torch.nn.functional.gelu(x, approximate="tanh")
def _silu(x):
    return torch.nn.functional.silu(x)
def _sigmoid(x):
    return torch.sigmoid(x)
def _layernorm(x, axis=-1, eps=1e-5):
    m = x.mean(dim=axis, keepdim=True)
    v = x.var(dim=axis, keepdim=True, unbiased=False)
    return (x - m) / torch.sqrt(v + eps)
def _scatter_add(tgt, idx, src, axis=0):
    return tgt.clone().index_add_(axis, idx, src)
def _segment_sum(src, seg, n):
    out = torch.zeros((n,) + src.shape[1:], dtype=src.dtype)
    return out.index_add_(0, seg, src)
def _pad(x, pw):
    flat = tuple(v for pair in reversed(pw) for v in pair)
    return torch.nn.functional.pad(x, flat)

kernel_name = 'concat_heads__linear_kernel_hedgehog__ssm_conv_s4__prompt'

def setup_inputs():

    _w = (lambda a: (lambda t: t.to(torch.bfloat16) if t.is_floating_point() else t)(torch.as_tensor(a)))
    def _A_setup():
        B, S, D, H = 1, 2048, 512, 32
        Dh = D // H
        return {
            "x": _w((lambda *s: torch.randn(*s, dtype=torch.bfloat16) * 0.4)(B, S, D)),
            "wqkv": _w((lambda *s: torch.randn(*s, dtype=torch.bfloat16) * 0.4)(D, 3 * D)),
            "w_phi": _w((lambda *s: torch.randn(*s, dtype=torch.bfloat16) * 0.4)(H, Dh, Dh) * (Dh ** -0.5)),
            "wo": _w((lambda *s: torch.randn(*s, dtype=torch.bfloat16) * 0.05)(D, D)),
        }
    _A_in = _A_setup()

    def _B_setup():
        B, L, D, N = 1, 2048, 512, 128
        A_re = -(lambda _x: torch.exp(torch.as_tensor(_x)))((lambda *s: torch.randn(*s, dtype=torch.bfloat16) * 6.4)(D, N))
        A_im = torch.pi * (lambda *s: torch.randn(*s, dtype=torch.bfloat16) * 0.1)(D, N)
        B_re = (lambda *s: torch.randn(*s, dtype=torch.bfloat16) * 0.2)(D, N)
        B_im = (lambda *s: torch.randn(*s, dtype=torch.bfloat16) * 0.2)(D, N)
        C_re = (lambda *s: torch.randn(*s, dtype=torch.bfloat16) * 0.2)(D, N)
        C_im = (lambda *s: torch.randn(*s, dtype=torch.bfloat16) * 0.2)(D, N)
        log_dt = (lambda *s: torch.randn(*s, dtype=torch.bfloat16) * 0.1)(D) * 0.5 - 4.0
        Dskip = (lambda *s: torch.randn(*s, dtype=torch.bfloat16) * 0.1)(D)
        return {
            "u": _w((lambda *s: torch.randn(*s, dtype=torch.bfloat16) * 0.05)(B, L, D)),
            "A_re": _w(A_re),
            "A_im": _w(A_im),
            "B_re": _w(B_re),
            "B_im": _w(B_im),
            "C_re": _w(C_re),
            "C_im": _w(C_im),
            "log_dt": _w(log_dt),
            "Dskip": _w(Dskip),
        }
    _B_in = _B_setup()

    return {
        "A_x": _A_in["x"],
        "A_wqkv": _A_in["wqkv"],
        "A_w_phi": _A_in["w_phi"],
        "A_wo": _A_in["wo"],
        "B_u": _B_in["u"],
        "B_A_re": _B_in["A_re"],
        "B_A_im": _B_in["A_im"],
        "B_B_re": _B_in["B_re"],
        "B_B_im": _B_in["B_im"],
        "B_C_re": _B_in["C_re"],
        "B_C_im": _B_in["C_im"],
        "B_log_dt": _B_in["log_dt"],
        "B_Dskip": _B_in["Dskip"],
    }

def reference(A_x, A_wqkv, A_w_phi, A_wo, B_u, B_A_re, B_A_im, B_B_re, B_B_im, B_C_re, B_C_im, B_log_dt, B_Dskip):
    def _A_ref(x, wqkv, w_phi, wo):
        B, S, D = x.shape
        H = 32; Dh = D // H
        qkv = (lambda x, *d: x.permute(*d))((x @ wqkv).reshape(B, S, 3, H, Dh), 2, 0, 3, 1, 4)
        q, k, v = qkv[0], qkv[1], qkv[2]
        pq = torch.einsum("bhsd,hdf->bhsf", q, w_phi)
        pk = torch.einsum("bhsd,hdf->bhsf", k, w_phi)
        phi_q = torch.concatenate([_softmax(pq, axis=-1), _softmax(-pq, axis=-1)], axis=-1)
        phi_k = torch.concatenate([_softmax(pk, axis=-1), _softmax(-pk, axis=-1)], axis=-1)
        kv = torch.einsum("bhsf,bhsd->bhfd", phi_k, v)
        z  = torch.einsum("bhsf->bhf", phi_k)
        num = torch.einsum("bhqf,bhfd->bhqd", phi_q, kv)
        den = torch.einsum("bhqf,bhf->bhq", phi_q, z)[..., None] + 1e-6
        o = num / den
        return (lambda x, *d: x.permute(*d))(o, 0, 2, 1, 3).reshape(B, S, D) @ wo

    def _B_ref(u, A_re, A_im, B_re, B_im, C_re, C_im, log_dt, Dskip):
        Bsz, L, D = u.shape
        dt = torch.exp(log_dt)[:, None]
        A = A_re + 1j * A_im
        Bc = B_re + 1j * B_im
        Cc = C_re + 1j * C_im
        logdA = dt * A
        dB = dt * Bc
        l = (lambda x, dt: x.to(dt))(torch.arange(L), A_re.dtype)
        P = torch.exp(logdA[:, :, None] * l[None, None, :])
        K = torch.einsum("dn,dnl,dn->dl", Cc, P, dB).real
        L2 = 2 * L
        Kp = _pad(K, ((0, 0), (0, L)))
        up = (lambda x, *d: x.permute(*d))(u, 0, 2, 1)
        up = _pad(up, ((0, 0), (0, 0), (0, L)))
        Kf = (lambda x, axes=(-2,-1): torch.fft.rfft2(x.float(), dim=axes))(Kp[:, None, :], axes=(-2, -1))
        Uf = (lambda x, axes=(-2,-1): torch.fft.rfft2(x.float(), dim=axes))(up[:, :, None, :], axes=(-2, -1))
        Yf = Uf * Kf[None, :, :, :]
        y = (lambda x, s, axes=(-2,-1): torch.fft.irfft2(x, s=s, dim=axes).to(torch.bfloat16))(Yf, (1, L2), axes=(-2, -1))[:, :, 0, :L]
        y = (lambda x, *d: x.permute(*d))(y, 0, 2, 1) + u * Dskip[None, None, :]
        return y

    a = _A_ref(A_x, A_wqkv, A_w_phi, A_wo)
    b = _B_ref(B_u, B_A_re, B_A_im, B_B_re, B_B_im, B_C_re, B_C_im, B_log_dt, B_Dskip)
    return torch.concatenate([a, b], axis=-1)
```

```asm
; @launch grid=(512,1,1) block=(256,1,1) lds=81920
.amdgcn_target "amdgcn-amd-amdhsa--gfx950"
.text
.globl concat_heads__linear_kernel_hedgehog__ssm_conv_s4__prompt_kernel
.p2align 8
.type concat_heads__linear_kernel_hedgehog__ssm_conv_s4__prompt_kernel,@function
concat_heads__linear_kernel_hedgehog__ssm_conv_s4__prompt_kernel:
    s_cmp_ge_u32 s2, 256
    s_cbranch_scc1 .LB
    s_setprio 3
    s_load_dwordx8 s[4:11], s[0:1], 0
    s_load_dwordx2 s[12:13], s[0:1], 104
    s_load_dwordx4 s[16:19], s[0:1], 112
    s_memrealtime s[70:71]
    v_and_b32 v1, 63, v0
    v_lshrrev_b32 v2, 6, v0
    s_and_b32 s40, s2, 7
    s_lshr_b32 s41, s2, 3
    v_readfirstlane_b32 s36, v2
    s_getreg_b32 s3, hwreg(HW_REG_XCC_ID, 0, 4)
    s_and_b32 s42, s41, 1
    s_lshl_b32 s37, s40, 1
    s_add_u32 s37, s37, s42
    s_lshr_b32 s38, s41, 1
    s_lshl_b32 s39, s42, 2
    s_and_b32 s14, s38, 1
    s_lshl_b32 s14, s14, 1
    s_add_u32 s39, s39, s14
    s_bfe_u32 s14, s38, 0x10001
    s_add_u32 s39, s39, s14
    s_and_b32 s14, s38, 4
    s_add_u32 s39, s39, s14
    s_add_u32 s39, s39, s40
    s_and_b32 s42, s41, 3
    s_lshl_b32 s14, s40, 2
    s_add_u32 s14, s14, s42
    s_lshr_b32 s15, s41, 2
    s_lshl_b32 s3, s3, 27
    v_lshrrev_b32 v21, 3, v1
    v_lshrrev_b32 v22, 4, v1
    v_and_b32 v23, 3, v1
    v_bfe_u32 v24, v1, 2, 2
    v_lshrrev_b32 v25, 5, v1
    v_and_b32 v26, 31, v1
    v_and_b32 v27, 15, v1
    s_lshl_b32 s40, s38, 10
    v_lshl_add_u32 v29, v1, 4, s40
    s_mul_i32 s40, s36, 49152
    s_lshl_b32 s41, s38, 6
    s_add_u32 s40, s40, s41
    v_lshrrev_b32 v28, 2, v1
    v_mul_u32_u24 v4, 3072, v28
    v_lshl_add_u32 v4, v23, 4, v4
    v_add_u32 v4, s40, v4
    s_lshl_b32 s40, s37, 17
    s_lshl_b32 s41, s36, 15
    s_add_u32 s40, s40, s41
    v_and_b32 v28, 7, v1
    v_xor_b32 v28, v28, v22
    v_lshlrev_b32 v2, 10, v21
    v_lshl_add_u32 v2, v28, 4, v2
    v_add_u32 v2, s40, v2
    v_xor_b32 v3, 64, v2
    s_lshl_b32 s44, s36, 12
    s_lshl_b32 s45, s36, 10
    s_add_u32 s40, s39, 0
    s_and_b32 s40, s40, 7
    s_lshl_b32 s52, s40, 7
    s_mul_i32 s60, s40, 196608
    s_add_u32 s40, s39, 1
    s_and_b32 s40, s40, 7
    s_lshl_b32 s53, s40, 7
    s_mul_i32 s61, s40, 196608
    s_add_u32 s40, s39, 2
    s_and_b32 s40, s40, 7
    s_lshl_b32 s54, s40, 7
    s_mul_i32 s62, s40, 196608
    s_add_u32 s40, s39, 3
    s_and_b32 s40, s40, 7
    s_lshl_b32 s55, s40, 7
    s_mul_i32 s63, s40, 196608
    s_add_u32 s40, s39, 4
    s_and_b32 s40, s40, 7
    s_lshl_b32 s56, s40, 7
    s_mul_i32 s64, s40, 196608
    s_add_u32 s40, s39, 5
    s_and_b32 s40, s40, 7
    s_lshl_b32 s57, s40, 7
    s_mul_i32 s65, s40, 196608
    s_add_u32 s40, s39, 6
    s_and_b32 s40, s40, 7
    s_lshl_b32 s58, s40, 7
    s_mul_i32 s66, s40, 196608
    s_add_u32 s40, s39, 7
    s_and_b32 s40, s40, 7
    s_lshl_b32 s59, s40, 7
    s_mul_i32 s67, s40, 196608
    s_waitcnt lgkmcnt(0)
    s_mov_b32 s20, s4
    s_mov_b32 s21, s5
    s_mov_b32 s22, 2097152
    s_mov_b32 s23, 0x00020000
    s_mov_b32 s24, s6
    s_mov_b32 s25, s7
    s_mov_b32 s26, 1572864
    s_mov_b32 s27, 0x00020000
    s_mov_b32 s28, s10
    s_mov_b32 s29, s11
    s_mov_b32 s30, 524288
    s_mov_b32 s31, 0x00020000
    s_mov_b32 s32, s8
    s_mov_b32 s33, s9
    s_mov_b32 s34, 16384
    s_mov_b32 s35, 0x00020000
    s_or_b32 s40, s2, s36
    s_cbranch_scc1 .Anon_1
    s_or_b32 s70, s70, 1
    s_bitset1_b32 s71, 31
    v_mov_b32 v125, 0
    v_mov_b32 v126, s70
    v_mov_b32 v127, s71
    s_mov_b64 exec, 1
    global_store_dwordx2 v125, v[126:127], s[16:17] sc1
    s_mov_b64 exec, -1
.Anon_1:
    s_add_u32 m0, s44, 65536
    s_nop 0
    buffer_load_dwordx4 v29, s[32:35], 0 offen lds
    s_add_u32 m0, s45, 0
    s_add_u32 s41, s60, 1024
    buffer_load_dwordx4 v4, s[24:27], s41 offen lds
    s_add_u32 m0, s45, 4096
    s_add_u32 s41, s61, 1024
    buffer_load_dwordx4 v4, s[24:27], s41 offen lds
    s_add_u32 m0, s44, 32768
    s_nop 0
    buffer_load_dwordx4 v2, s[20:23], s52 offen lds
    s_add_u32 m0, s44, 33792
    s_add_u32 s52, s52, 8192
    buffer_load_dwordx4 v3, s[20:23], s52 offen lds
    s_add_u32 m0, s44, 34816
    s_add_u32 s52, s52, 8192
    buffer_load_dwordx4 v2, s[20:23], s52 offen lds
    s_add_u32 m0, s44, 35840
    s_add_u32 s52, s52, 8192
    buffer_load_dwordx4 v3, s[20:23], s52 offen lds
    s_add_u32 m0, s45, 8192
    s_add_u32 s41, s62, 1024
    buffer_load_dwordx4 v4, s[24:27], s41 offen lds
    s_add_u32 m0, s45, 12288
    s_add_u32 s41, s63, 1024
    buffer_load_dwordx4 v4, s[24:27], s41 offen lds
    s_add_u32 m0, s45, 16384
    s_add_u32 s41, s64, 1024
    buffer_load_dwordx4 v4, s[24:27], s41 offen lds
    s_add_u32 m0, s45, 20480
    s_add_u32 s41, s65, 1024
    buffer_load_dwordx4 v4, s[24:27], s41 offen lds
    s_add_u32 m0, s45, 24576
    s_add_u32 s41, s66, 1024
    buffer_load_dwordx4 v4, s[24:27], s41 offen lds
    s_add_u32 m0, s45, 28672
    s_add_u32 s41, s67, 1024
    buffer_load_dwordx4 v4, s[24:27], s41 offen lds
    s_add_u32 m0, s44, 49152
    s_nop 0
    buffer_load_dwordx4 v2, s[20:23], s53 offen lds
    s_add_u32 m0, s44, 50176
    s_add_u32 s53, s53, 8192
    buffer_load_dwordx4 v3, s[20:23], s53 offen lds
    s_add_u32 m0, s44, 51200
    s_add_u32 s53, s53, 8192
    buffer_load_dwordx4 v2, s[20:23], s53 offen lds
    s_add_u32 m0, s44, 52224
    s_add_u32 s53, s53, 8192
    buffer_load_dwordx4 v3, s[20:23], s53 offen lds
    v_bfe_u32 v28, v26, 1, 3
    v_xor_b32 v28, v28, v25
    v_lshlrev_b32 v6, 7, v26
    v_lshl_add_u32 v6, v28, 4, v6
    s_add_u32 s40, s44, 32768
    v_add_u32 v6, s40, v6
    v_xor_b32 v7, 32, v6
    v_xor_b32 v8, 64, v6
    v_xor_b32 v9, 96, v6
    v_and_b32 v28, 1, v23
    v_lshlrev_b32 v30, 5, v28
    v_and_b32 v31, 1, v22
    v_lshl_add_u32 v30, v31, 4, v30
    v_lshrrev_b32 v5, 1, v23
    v_lshl_add_u32 v30, v5, 3, v30
    v_lshlrev_b32 v29, 9, v28
    v_lshl_add_u32 v29, v24, 5, v29
    v_lshl_add_u32 v29, v31, 4, v29
    v_lshl_add_u32 v29, v5, 3, v29
    s_add_u32 s40, s44, 65536
    v_add_u32 v29, s40, v29
    v_lshl_add_u32 v31, v25, 3, v24
    v_lshl_add_u32 v10, v31, 6, v30
    v_add_u32 v11, 32768, v10
    v_bfe_u32 v28, v1, 2, 1
    v_cmp_eq_u32_e64 s[46:47], v28, v25
    s_waitcnt vmcnt(16)
    ds_read_b64_tr_b16 v[96:97], v29 offset:0
    ds_read_b64_tr_b16 v[98:99], v29 offset:128
    ds_read_b64_tr_b16 v[100:101], v29 offset:256
    ds_read_b64_tr_b16 v[102:103], v29 offset:384
    s_mul_i32 s40, s36, 7168
    v_mul_u32_u24 v16, 224, v26
    v_add_u32 v16, s40, v16
    v_lshl_add_u32 v15, v25, 6, v16
    v_lshl_add_u32 v16, v25, 5, v16
    v_add_u32 v16, 128, v16
    s_mov_b32 s48, 0x3fb8aa3b
    s_waitcnt lgkmcnt(0)
    s_add_u32 m0, s44, 65536
    s_nop 0
    buffer_load_dwordx4 v2, s[20:23], s54 offen lds
    s_add_u32 m0, s44, 66560
    s_add_u32 s54, s54, 8192
    buffer_load_dwordx4 v3, s[20:23], s54 offen lds
    s_add_u32 m0, s44, 67584
    s_add_u32 s54, s54, 8192
    buffer_load_dwordx4 v2, s[20:23], s54 offen lds
    s_add_u32 m0, s44, 68608
    s_add_u32 s54, s54, 8192
    buffer_load_dwordx4 v3, s[20:23], s54 offen lds
    v_cndmask_b32_e64 v96, 0, v96, s[46:47]
    v_cndmask_b32_e64 v97, 0, v97, s[46:47]
    v_cndmask_b32_e64 v98, 0, v98, s[46:47]
    v_cndmask_b32_e64 v99, 0, v99, s[46:47]
    v_cndmask_b32_e64 v100, 0, v100, s[46:47]
    v_cndmask_b32_e64 v101, 0, v101, s[46:47]
    v_cndmask_b32_e64 v102, 0, v102, s[46:47]
    v_cndmask_b32_e64 v103, 0, v103, s[46:47]
    s_lshl_b32 s40, s15, 7
    v_and_b32 v28, 1, v22
    v_and_b32 v29, 7, v1
    v_xor_b32 v28, v28, v29
    v_lshlrev_b32 v12, 10, v21
    v_lshl_add_u32 v12, v28, 4, v12
    v_add_u32 v12, s40, v12
    v_xor_b32 v13, 64, v12
    s_mul_i32 s40, s37, 139264
    s_mul_i32 s41, s36, 34816
    s_add_u32 s40, s40, s41
    s_lshl_b32 s41, s38, 10
    s_add_u32 s40, s40, s41
    s_add_u32 s40, s40, 1048576
    v_and_b32 v14, 1, v22
    v_mul_u32_u24 v14, 17408, v14
    v_lshl_add_u32 v14, v25, 9, v14
    v_lshl_add_u32 v14, v27, 4, v14
    v_add_u32 v14, s40, v14
    v_lshl_add_u32 v28, v22, 2, v24
    v_mul_u32_u24 v17, 224, v28
    v_lshl_add_u32 v17, v23, 3, v17
    s_lshr_b32 s40, s36, 1
    s_lshl_b32 s41, s40, 5
    s_add_u32 s41, s41, 128
    v_add_u32 v18, s41, v17
    s_lshl_b32 s41, s36, 5
    v_add_u32 v17, s41, v17
    s_and_b32 s41, s36, 1
    s_lshl_b32 s41, s41, 1
    s_lshl_b32 s42, s38, 2
    s_add_u32 s41, s41, s42
    s_mul_i32 s41, s41, 12288
    s_lshl_b32 s42, s37, 8
    s_add_u32 s41, s41, s42
    s_add_u32 s41, s41, 0
    s_lshl_b32 s42, s40, 12
    s_add_u32 s42, s42, s41
    s_add_u32 s41, s41, 8192
    v_mul_u32_u24 v19, 12288, v25
    v_lshl_add_u32 v19, v27, 4, v19
    v_and_b32 v28, 1, v22
    v_lshl_add_u32 v19, v28, 3, v19
    v_add_u32 v20, s41, v19
    v_add_u32 v19, s42, v19
    v_and_b32 v28, 1, v1
    v_cmp_eq_u32_e64 s[50:51], s40, v28
    s_lshl_b32 s40, s37, 2
    s_add_u32 s40, s40, s36
    s_lshl_b32 s41, s40, 3
    s_lshl_b32 s42, s38, 9
    s_add_u32 s41, s41, s42
    s_add_u32 s41, s41, 802816
    s_lshl_b32 s40, s40, 7
    s_lshl_b32 s42, s38, 3
    s_add_u32 s40, s40, s42
    s_add_u32 s8, s40, 819200
    s_and_b32 s40, s2, 7
    s_lshl_b32 s40, s40, 10
    s_lshl_b32 s42, s36, 8
    s_add_u32 s40, s40, s42
    s_add_u32 s9, s40, 835584
    s_and_b32 s42, s2, 0xf8
    s_add_u32 s40, s9, s42
    v_mov_b32 v5, s41
    v_writelane_b32 v5, s40, 1
    v_mov_b32 v21, 0
    v_mov_b32 v120, -1
    v_mov_b32 v121, -1
    v_mov_b32 v122, -1
    v_mov_b32 v123, -1
    s_waitcnt vmcnt(8)
    s_barrier
    ds_read_b64_tr_b16 v[80:81], v10 offset:0
    ds_read_b64_tr_b16 v[82:83], v10 offset:256
    ds_read_b64_tr_b16 v[84:85], v10 offset:1024
    ds_read_b64_tr_b16 v[86:87], v10 offset:1280
    ds_read_b64_tr_b16 v[88:89], v10 offset:2048
    ds_read_b64_tr_b16 v[90:91], v10 offset:2304
    ds_read_b64_tr_b16 v[92:93], v10 offset:3072
    ds_read_b64_tr_b16 v[94:95], v10 offset:3328
    s_waitcnt vmcnt(14)
    ds_read_b128 v[128:131], v6 offset:0
    ds_read_b128 v[132:135], v7 offset:0
    ds_read_b128 v[136:139], v8 offset:0
    ds_read_b128 v[140:143], v9 offset:0
    s_waitcnt lgkmcnt(3)
    v_mfma_f32_32x32x16_bf16 v[32:47], v[80:83], v[128:131], 0
    s_waitcnt lgkmcnt(2)
    v_mfma_f32_32x32x16_bf16 v[32:47], v[84:87], v[132:135], v[32:47]
    s_waitcnt lgkmcnt(1)
    v_mfma_f32_32x32x16_bf16 v[32:47], v[88:91], v[136:139], v[32:47]
    s_waitcnt lgkmcnt(0)
    v_mfma_f32_32x32x16_bf16 v[32:47], v[92:95], v[140:143], v[32:47]
    s_add_u32 m0, s44, 32768
    s_nop 0
    buffer_load_dwordx4 v2, s[20:23], s55 offen lds
    s_add_u32 m0, s44, 33792
    s_add_u32 s55, s55, 8192
    buffer_load_dwordx4 v3, s[20:23], s55 offen lds
    s_add_u32 m0, s44, 34816
    s_add_u32 s55, s55, 8192
    buffer_load_dwordx4 v2, s[20:23], s55 offen lds
    s_add_u32 m0, s44, 35840
    s_add_u32 s55, s55, 8192
    buffer_load_dwordx4 v3, s[20:23], s55 offen lds
    ds_read_b64_tr_b16 v[64:65], v10 offset:4096
    ds_read_b64_tr_b16 v[66:67], v10 offset:4352
    ds_read_b64_tr_b16 v[68:69], v10 offset:5120
    ds_read_b64_tr_b16 v[70:71], v10 offset:5376
    ds_read_b64_tr_b16 v[72:73], v10 offset:6144
    ds_read_b64_tr_b16 v[74:75], v10 offset:6400
    ds_read_b64_tr_b16 v[76:77], v10 offset:7168
    ds_read_b64_tr_b16 v[78:79], v10 offset:7424
    s_waitcnt vmcnt(8)
    ds_read_b128 v[144:147], v6 offset:16384
    ds_read_b128 v[148:151], v7 offset:16384
    ds_read_b128 v[152:155], v8 offset:16384
    ds_read_b128 v[156:159], v9 offset:16384
    s_waitcnt lgkmcnt(3)
    v_mfma_f32_32x32x16_bf16 v[32:47], v[64:67], v[144:147], v[32:47]
    s_waitcnt lgkmcnt(2)
    v_mfma_f32_32x32x16_bf16 v[32:47], v[68:71], v[148:151], v[32:47]
    s_waitcnt lgkmcnt(1)
    v_mfma_f32_32x32x16_bf16 v[32:47], v[72:75], v[152:155], v[32:47]
    s_waitcnt lgkmcnt(0)
    v_mfma_f32_32x32x16_bf16 v[32:47], v[76:79], v[156:159], v[32:47]
    s_add_u32 m0, s44, 49152
    s_nop 0
    buffer_load_dwordx4 v2, s[20:23], s56 offen lds
    s_add_u32 m0, s44, 50176
    s_add_u32 s56, s56, 8192
    buffer_load_dwordx4 v3, s[20:23], s56 offen lds
    s_add_u32 m0, s44, 51200
    s_add_u32 s56, s56, 8192
    buffer_load_dwordx4 v2, s[20:23], s56 offen lds
    s_add_u32 m0, s44, 52224
    s_add_u32 s56, s56, 8192
    buffer_load_dwordx4 v3, s[20:23], s56 offen lds
    ds_read_b64_tr_b16 v[80:81], v10 offset:8192
    ds_read_b64_tr_b16 v[82:83], v10 offset:8448
    ds_read_b64_tr_b16 v[84:85], v10 offset:9216
    ds_read_b64_tr_b16 v[86:87], v10 offset:9472
    ds_read_b64_tr_b16 v[88:89], v10 offset:10240
    ds_read_b64_tr_b16 v[90:91], v10 offset:10496
    ds_read_b64_tr_b16 v[92:93], v10 offset:11264
    ds_read_b64_tr_b16 v[94:95], v10 offset:11520
    s_waitcnt vmcnt(8)
    ds_read_b128 v[160:163], v6 offset:32768
    ds_read_b128 v[164:167], v7 offset:32768
    ds_read_b128 v[168:171], v8 offset:32768
    ds_read_b128 v[172:175], v9 offset:32768
    s_waitcnt lgkmcnt(3)
    v_mfma_f32_32x32x16_bf16 v[32:47], v[80:83], v[160:163], v[32:47]
    s_waitcnt lgkmcnt(2)
    v_mfma_f32_32x32x16_bf16 v[32:47], v[84:87], v[164:167], v[32:47]
    s_waitcnt lgkmcnt(1)
    v_mfma_f32_32x32x16_bf16 v[32:47], v[88:91], v[168:171], v[32:47]
    s_waitcnt lgkmcnt(0)
    v_mfma_f32_32x32x16_bf16 v[32:47], v[92:95], v[172:175], v[32:47]
    s_add_u32 m0, s44, 65536
    s_nop 0
    buffer_load_dwordx4 v2, s[20:23], s57 offen lds
    s_add_u32 m0, s44, 66560
    s_add_u32 s57, s57, 8192
    buffer_load_dwordx4 v3, s[20:23], s57 offen lds
    s_add_u32 m0, s44, 67584
    s_add_u32 s57, s57, 8192
    buffer_load_dwordx4 v2, s[20:23], s57 offen lds
    s_add_u32 m0, s44, 68608
    s_add_u32 s57, s57, 8192
    buffer_load_dwordx4 v3, s[20:23], s57 offen lds
    ds_read_b64_tr_b16 v[64:65], v10 offset:12288
    ds_read_b64_tr_b16 v[66:67], v10 offset:12544
    ds_read_b64_tr_b16 v[68:69], v10 offset:13312
    ds_read_b64_tr_b16 v[70:71], v10 offset:13568
    ds_read_b64_tr_b16 v[72:73], v10 offset:14336
    ds_read_b64_tr_b16 v[74:75], v10 offset:14592
    ds_read_b64_tr_b16 v[76:77], v10 offset:15360
    ds_read_b64_tr_b16 v[78:79], v10 offset:15616
    s_waitcnt vmcnt(8)
    ds_read_b128 v[176:179], v6 offset:0
    ds_read_b128 v[180:183], v7 offset:0
    ds_read_b128 v[184:187], v8 offset:0
    ds_read_b128 v[188:191], v9 offset:0
    s_waitcnt lgkmcnt(3)
    v_mfma_f32_32x32x16_bf16 v[32:47], v[64:67], v[176:179], v[32:47]
    s_waitcnt lgkmcnt(2)
    v_mfma_f32_32x32x16_bf16 v[32:47], v[68:71], v[180:183], v[32:47]
    s_waitcnt lgkmcnt(1)
    v_mfma_f32_32x32x16_bf16 v[32:47], v[72:75], v[184:187], v[32:47]
    s_waitcnt lgkmcnt(0)
    v_mfma_f32_32x32x16_bf16 v[32:47], v[76:79], v[188:191], v[32:47]
    s_add_u32 m0, s44, 32768
    s_nop 0
    buffer_load_dwordx4 v2, s[20:23], s58 offen lds
    s_add_u32 m0, s44, 33792
    s_add_u32 s58, s58, 8192
    buffer_load_dwordx4 v3, s[20:23], s58 offen lds
    s_add_u32 m0, s44, 34816
    s_add_u32 s58, s58, 8192
    buffer_load_dwordx4 v2, s[20:23], s58 offen lds
    s_add_u32 m0, s44, 35840
    s_add_u32 s58, s58, 8192
    buffer_load_dwordx4 v3, s[20:23], s58 offen lds
    ds_read_b64_tr_b16 v[80:81], v10 offset:16384
    ds_read_b64_tr_b16 v[82:83], v10 offset:16640
    ds_read_b64_tr_b16 v[84:85], v10 offset:17408
    ds_read_b64_tr_b16 v[86:87], v10 offset:17664
    ds_read_b64_tr_b16 v[88:89], v10 offset:18432
    ds_read_b64_tr_b16 v[90:91], v10 offset:18688
    ds_read_b64_tr_b16 v[92:93], v10 offset:19456
    ds_read_b64_tr_b16 v[94:95], v10 offset:19712
    s_waitcnt vmcnt(8)
    ds_read_b128 v[192:195], v6 offset:16384
    ds_read_b128 v[196:199], v7 offset:16384
    ds_read_b128 v[200:203], v8 offset:16384
    ds_read_b128 v[204:207], v9 offset:16384
    s_waitcnt lgkmcnt(3)
    v_mfma_f32_32x32x16_bf16 v[32:47], v[80:83], v[192:195], v[32:47]
    s_waitcnt lgkmcnt(2)
    v_mfma_f32_32x32x16_bf16 v[32:47], v[84:87], v[196:199], v[32:47]
    s_waitcnt lgkmcnt(1)
    v_mfma_f32_32x32x16_bf16 v[32:47], v[88:91], v[200:203], v[32:47]
    s_waitcnt lgkmcnt(0)
    v_mfma_f32_32x32x16_bf16 v[32:47], v[92:95], v[204:207], v[32:47]
    s_add_u32 m0, s44, 49152
    s_nop 0
    buffer_load_dwordx4 v2, s[20:23], s59 offen lds
    s_add_u32 m0, s44, 50176
    s_add_u32 s59, s59, 8192
    buffer_load_dwordx4 v3, s[20:23], s59 offen lds
    s_add_u32 m0, s44, 51200
    s_add_u32 s59, s59, 8192
    buffer_load_dwordx4 v2, s[20:23], s59 offen lds
    s_add_u32 m0, s44, 52224
    s_add_u32 s59, s59, 8192
    buffer_load_dwordx4 v3, s[20:23], s59 offen lds
    global_store_dwordx2 v19, v[120:121], s[18:19] sc1
    s_mov_b64 exec, s[50:51]
    global_store_dwordx2 v20, v[120:121], s[18:19] sc1
    s_mov_b64 exec, -1
    global_load_dwordx2 v[28:29], v21, s[16:17]
    ds_read_b64_tr_b16 v[64:65], v10 offset:20480
    ds_read_b64_tr_b16 v[66:67], v10 offset:20736
    ds_read_b64_tr_b16 v[68:69], v10 offset:21504
    ds_read_b64_tr_b16 v[70:71], v10 offset:21760
    ds_read_b64_tr_b16 v[72:73], v10 offset:22528
    ds_read_b64_tr_b16 v[74:75], v10 offset:22784
    ds_read_b64_tr_b16 v[76:77], v10 offset:23552
    ds_read_b64_tr_b16 v[78:79], v10 offset:23808
    s_waitcnt vmcnt(11)
    ds_read_b128 v[208:211], v6 offset:32768
    ds_read_b128 v[212:215], v7 offset:32768
    ds_read_b128 v[216:219], v8 offset:32768
    ds_read_b128 v[220:223], v9 offset:32768
    s_waitcnt lgkmcnt(3)
    v_mfma_f32_32x32x16_bf16 v[32:47], v[64:67], v[208:211], v[32:47]
    s_waitcnt lgkmcnt(2)
    v_mfma_f32_32x32x16_bf16 v[32:47], v[68:71], v[212:215], v[32:47]
    s_waitcnt lgkmcnt(1)
    v_mfma_f32_32x32x16_bf16 v[32:47], v[72:75], v[216:219], v[32:47]
    s_waitcnt lgkmcnt(0)
    v_mfma_f32_32x32x16_bf16 v[32:47], v[76:79], v[220:223], v[32:47]
    s_add_u32 m0, s44, 65536
    s_add_u32 s41, s60, 2048
    buffer_load_dwordx4 v4, s[24:27], s41 offen lds
    s_add_u32 m0, s44, 66560
    s_add_u32 s41, s61, 2048
    buffer_load_dwordx4 v4, s[24:27], s41 offen lds
    s_add_u32 m0, s44, 67584
    s_add_u32 s41, s62, 2048
    buffer_load_dwordx4 v4, s[24:27], s41 offen lds
    s_add_u32 m0, s44, 68608
    s_add_u32 s41, s63, 2048
    buffer_load_dwordx4 v4, s[24:27], s41 offen lds
    ds_read_b64_tr_b16 v[80:81], v10 offset:24576
    ds_read_b64_tr_b16 v[82:83], v10 offset:24832
    ds_read_b64_tr_b16 v[84:85], v10 offset:25600
    ds_read_b64_tr_b16 v[86:87], v10 offset:25856
    ds_read_b64_tr_b16 v[88:89], v10 offset:26624
    ds_read_b64_tr_b16 v[90:91], v10 offset:26880
    ds_read_b64_tr_b16 v[92:93], v10 offset:27648
    ds_read_b64_tr_b16 v[94:95], v10 offset:27904
    s_waitcnt vmcnt(11)
    ds_read_b128 v[224:227], v6 offset:0
    ds_read_b128 v[228:231], v7 offset:0
    ds_read_b128 v[232:235], v8 offset:0
    ds_read_b128 v[236:239], v9 offset:0
    s_waitcnt lgkmcnt(3)
    v_mfma_f32_32x32x16_bf16 v[32:47], v[80:83], v[224:227], v[32:47]
    s_waitcnt lgkmcnt(2)
    v_mfma_f32_32x32x16_bf16 v[32:47], v[84:87], v[228:231], v[32:47]
    s_waitcnt lgkmcnt(1)
    v_mfma_f32_32x32x16_bf16 v[32:47], v[88:91], v[232:235], v[32:47]
    s_waitcnt lgkmcnt(0)
    v_mfma_f32_32x32x16_bf16 v[32:47], v[92:95], v[236:239], v[32:47]
    ds_read_b64_tr_b16 v[64:65], v10 offset:28672
    ds_read_b64_tr_b16 v[66:67], v10 offset:28928
    ds_read_b64_tr_b16 v[68:69], v10 offset:29696
    ds_read_b64_tr_b16 v[70:71], v10 offset:29952
    ds_read_b64_tr_b16 v[72:73], v10 offset:30720
    ds_read_b64_tr_b16 v[74:75], v10 offset:30976
    ds_read_b64_tr_b16 v[76:77], v10 offset:31744
    ds_read_b64_tr_b16 v[78:79], v10 offset:32000
    s_waitcnt vmcnt(7)
    ds_read_b128 v[240:243], v6 offset:16384
    ds_read_b128 v[244:247], v7 offset:16384
    ds_read_b128 v[248:251], v8 offset:16384
    ds_read_b128 v[252:255], v9 offset:16384
    s_waitcnt lgkmcnt(3)
    v_mfma_f32_32x32x16_bf16 v[32:47], v[64:67], v[240:243], v[32:47]
    s_waitcnt lgkmcnt(2)
    v_mfma_f32_32x32x16_bf16 v[32:47], v[68:71], v[244:247], v[32:47]
    s_waitcnt lgkmcnt(1)
    v_mfma_f32_32x32x16_bf16 v[32:47], v[72:75], v[248:251], v[32:47]
    s_waitcnt lgkmcnt(0)
    v_mfma_f32_32x32x16_bf16 v[32:47], v[76:79], v[252:255], v[32:47]
    s_nop 11
    v_cvt_pk_bf16_f32 v120, v32, v33
    v_cvt_pk_bf16_f32 v121, v34, v35
    v_cvt_pk_bf16_f32 v122, v36, v37
    v_cvt_pk_bf16_f32 v123, v38, v39
    v_cvt_pk_bf16_f32 v124, v40, v41
    v_cvt_pk_bf16_f32 v125, v42, v43
    v_cvt_pk_bf16_f32 v126, v44, v45
    v_cvt_pk_bf16_f32 v127, v46, v47
    v_mfma_f32_32x32x16_bf16 v[32:47], v[96:99], v[120:123], 0
    s_nop 0
    v_mfma_f32_32x32x16_bf16 v[32:47], v[100:103], v[124:127], v[32:47]
    s_add_u32 m0, s44, 32768
    s_add_u32 s41, s64, 2048
    buffer_load_dwordx4 v4, s[24:27], s41 offen lds
    s_nop 8
    v_max3_f32 v120, v32, v33, v34
    v_min3_f32 v121, v32, v33, v34
    v_max3_f32 v122, v35, v36, v37
    v_min3_f32 v123, v35, v36, v37
    v_max3_f32 v120, v120, v38, v39
    v_min3_f32 v121, v121, v38, v39
    v_max3_f32 v122, v122, v40, v41
    v_min3_f32 v123, v123, v40, v41
    v_max3_f32 v120, v120, v42, v43
    v_min3_f32 v121, v121, v42, v43
    v_max3_f32 v122, v122, v44, v45
    v_min3_f32 v123, v123, v44, v45
    v_max3_f32 v120, v120, v46, v47
    v_min3_f32 v121, v121, v46, v47
    s_add_u32 m0, s44, 33792
    s_add_u32 s41, s65, 2048
    buffer_load_dwordx4 v4, s[24:27], s41 offen lds
    v_max_f32 v120, v120, v122
    v_min_f32 v121, v121, v123
    v_mul_f32_e64 v120, -v120, s48
    v_mul_f32 v121, s48, v121
    v_fma_f32 v64, -v32, s48, v121
    v_fma_f32 v32, v32, s48, v120
    v_fma_f32 v65, -v33, s48, v121
    v_fma_f32 v33, v33, s48, v120
    v_exp_f32 v64, v64
    v_exp_f32 v32, v32
    v_fma_f32 v66, -v34, s48, v121
    v_fma_f32 v34, v34, s48, v120
    s_add_u32 m0, s44, 34816
    s_add_u32 s41, s66, 2048
    buffer_load_dwordx4 v4, s[24:27], s41 offen lds
    v_exp_f32 v65, v65
    v_exp_f32 v33, v33
    v_fma_f32 v67, -v35, s48, v121
    v_fma_f32 v35, v35, s48, v120
    v_exp_f32 v66, v66
    v_exp_f32 v34, v34
    v_add_f32 v124, v32, v33
    v_add_f32 v125, v64, v65
    v_fma_f32 v68, -v36, s48, v121
    v_fma_f32 v36, v36, s48, v120
    v_exp_f32 v67, v67
    v_exp_f32 v35, v35
    s_add_u32 m0, s44, 35840
    s_add_u32 s41, s67, 2048
    buffer_load_dwordx4 v4, s[24:27], s41 offen lds
    v_add_f32 v124, v124, v34
    v_add_f32 v125, v125, v66
    v_fma_f32 v69, -v37, s48, v121
    v_fma_f32 v37, v37, s48, v120
    v_exp_f32 v68, v68
    v_exp_f32 v36, v36
    v_add_f32 v124, v124, v35
    v_add_f32 v125, v125, v67
    v_fma_f32 v70, -v38, s48, v121
    v_fma_f32 v38, v38, s48, v120
    v_exp_f32 v69, v69
    v_exp_f32 v37, v37
    v_add_f32 v124, v124, v36
    v_add_f32 v125, v125, v68
    v_fma_f32 v71, -v39, s48, v121
    v_fma_f32 v39, v39, s48, v120
    v_exp_f32 v70, v70
    v_exp_f32 v38, v38
    v_add_f32 v124, v124, v37
    v_add_f32 v125, v125, v69
    s_waitcnt vmcnt(4)
    v_readfirstlane_b32 s4, v28
    v_readfirstlane_b32 s5, v29
    s_mov_b32 s77, 0x40000
.Anonce_2:
    s_min_u32 s40, s4, s5
    s_cmp_lg_u32 s40, 0
    s_cbranch_scc1 .Anonced_3
    s_sub_u32 s77, s77, 1
    s_cbranch_scc1 .Anonced_3
    global_load_dwordx2 v[28:29], v21, s[16:17] sc1
    s_waitcnt vmcnt(0)
    v_readfirstlane_b32 s4, v28
    v_readfirstlane_b32 s5, v29
    s_branch .Anonce_2
.Anonced_3:
    s_or_b32 s7, s5, s3
    s_mov_b32 s6, s4
    v_writelane_b32 v29, s7, 1
    s_mov_b64 exec, 3
    global_store_dwordx2 v5, v[28:29], s[18:19] sc1
    s_mov_b64 exec, -1
    s_barrier
    ds_read_b64_tr_b16 v[80:81], v11 offset:32768
    ds_read_b64_tr_b16 v[82:83], v11 offset:33024
    ds_read_b64_tr_b16 v[84:85], v11 offset:36864
    ds_read_b64_tr_b16 v[86:87], v11 offset:37120
    ds_read_b64_tr_b16 v[88:89], v11 offset:40960
    ds_read_b64_tr_b16 v[90:91], v11 offset:41216
    v_fma_f32 v72, -v40, s48, v121
    v_fma_f32 v40, v40, s48, v120
    v_exp_f32 v71, v71
    s_waitcnt lgkmcnt(4)
    v_mfma_f32_32x32x16_bf16 v[48:63], v[80:83], v[128:131], 0
    ds_read_b64_tr_b16 v[92:93], v11 offset:45056
    ds_read_b64_tr_b16 v[94:95], v11 offset:45312
    s_add_u32 m0, s44, 49152
    s_add_u32 s41, s60, 0
    buffer_load_dwordx4 v4, s[24:27], s41 offen lds
    v_exp_f32 v39, v39
    v_add_f32 v124, v124, v38
    v_add_f32 v125, v125, v70
    s_waitcnt lgkmcnt(4)
    v_mfma_f32_32x32x16_bf16 v[48:63], v[84:87], v[132:135], v[48:63]
    ds_read_b64_tr_b16 v[80:81], v11 offset:33792
    ds_read_b64_tr_b16 v[82:83], v11 offset:34048
    v_fma_f32 v73, -v41, s48, v121
    v_fma_f32 v41, v41, s48, v120
    v_exp_f32 v72, v72
    s_waitcnt lgkmcnt(4)
    v_mfma_f32_32x32x16_bf16 v[48:63], v[88:91], v[136:139], v[48:63]
    ds_read_b64_tr_b16 v[84:85], v11 offset:37888
    ds_read_b64_tr_b16 v[86:87], v11 offset:38144
    v_exp_f32 v40, v40
    v_add_f32 v124, v124, v39
    v_add_f32 v125, v125, v71
    s_waitcnt lgkmcnt(4)
    v_mfma_f32_32x32x16_bf16 v[48:63], v[92:95], v[140:143], v[48:63]
    ds_read_b64_tr_b16 v[88:89], v11 offset:41984
    ds_read_b64_tr_b16 v[90:91], v11 offset:42240
    v_fma_f32 v74, -v42, s48, v121
    v_fma_f32 v42, v42, s48, v120
    v_exp_f32 v73, v73
    s_waitcnt lgkmcnt(4)
    v_mfma_f32_32x32x16_bf16 v[48:63], v[80:83], v[144:147], v[48:63]
    ds_read_b64_tr_b16 v[92:93], v11 offset:46080
    ds_read_b64_tr_b16 v[94:95], v11 offset:46336
    s_add_u32 m0, s44, 50176
    s_add_u32 s41, s61, 0
    buffer_load_dwordx4 v4, s[24:27], s41 offen lds
    v_exp_f32 v41, v41
    v_add_f32 v124, v124, v40
    v_add_f32 v125, v125, v72
    s_waitcnt lgkmcnt(4)
    v_mfma_f32_32x32x16_bf16 v[48:63], v[84:87], v[148:151], v[48:63]
    ds_read_b64_tr_b16 v[80:81], v11 offset:34816
    ds_read_b64_tr_b16 v[82:83], v11 offset:35072
    v_fma_f32 v75, -v43, s48, v121
    v_fma_f32 v43, v43, s48, v120
    v_exp_f32 v74, v74
    s_waitcnt lgkmcnt(4)
    v_mfma_f32_32x32x16_bf16 v[48:63], v[88:91], v[152:155], v[48:63]
    ds_read_b64_tr_b16 v[84:85], v11 offset:38912
    ds_read_b64_tr_b16 v[86:87], v11 offset:39168
    v_exp_f32 v42, v42
    v_add_f32 v124, v124, v41
    v_add_f32 v125, v125, v73
    s_waitcnt lgkmcnt(4)
    v_mfma_f32_32x32x16_bf16 v[48:63], v[92:95], v[156:159], v[48:63]
    ds_read_b64_tr_b16 v[88:89], v11 offset:43008
    ds_read_b64_tr_b16 v[90:91], v11 offset:43264
    v_fma_f32 v76, -v44, s48, v121
    v_fma_f32 v44, v44, s48, v120
    v_exp_f32 v75, v75
    s_waitcnt lgkmcnt(4)
    v_mfma_f32_32x32x16_bf16 v[48:63], v[80:83], v[160:163], v[48:63]
    ds_read_b64_tr_b16 v[92:93], v11 offset:47104
    ds_read_b64_tr_b16 v[94:95], v11 offset:47360
    s_add_u32 m0, s44, 51200
    s_add_u32 s41, s62, 0
    buffer_load_dwordx4 v4, s[24:27], s41 offen lds
    v_exp_f32 v43, v43
    v_add_f32 v124, v124, v42
    v_add_f32 v125, v125, v74
    s_waitcnt lgkmcnt(4)
    v_mfma_f32_32x32x16_bf16 v[48:63], v[84:87], v[164:167], v[48:63]
    ds_read_b64_tr_b16 v[80:81], v11 offset:35840
    ds_read_b64_tr_b16 v[82:83], v11 offset:36096
    v_fma_f32 v77, -v45, s48, v121
    v_fma_f32 v45, v45, s48, v120
    v_exp_f32 v76, v76
    s_waitcnt lgkmcnt(4)
    v_mfma_f32_32x32x16_bf16 v[48:63], v[88:91], v[168:171], v[48:63]
    ds_read_b64_tr_b16 v[84:85], v11 offset:39936
    ds_read_b64_tr_b16 v[86:87], v11 offset:40192
    v_exp_f32 v44, v44
    v_add_f32 v124, v124, v43
    v_add_f32 v125, v125, v75
    s_waitcnt lgkmcnt(4)
    v_mfma_f32_32x32x16_bf16 v[48:63], v[92:95], v[172:175], v[48:63]
    ds_read_b64_tr_b16 v[88:89], v11 offset:44032
    ds_read_b64_tr_b16 v[90:91], v11 offset:44288
    v_fma_f32 v78, -v46, s48, v121
    v_fma_f32 v46, v46, s48, v120
    v_exp_f32 v77, v77
    s_waitcnt lgkmcnt(4)
    v_mfma_f32_32x32x16_bf16 v[48:63], v[80:83], v[176:179], v[48:63]
    ds_read_b64_tr_b16 v[92:93], v11 offset:48128
    ds_read_b64_tr_b16 v[94:95], v11 offset:48384
    s_waitcnt vmcnt(4)
    s_barrier
    s_add_u32 m0, s44, 52224
    s_add_u32 s41, s63, 0
    buffer_load_dwordx4 v4, s[24:27], s41 offen lds
    v_exp_f32 v45, v45
    v_add_f32 v124, v124, v44
    v_add_f32 v125, v125, v76
    s_waitcnt lgkmcnt(4)
    v_mfma_f32_32x32x16_bf16 v[48:63], v[84:87], v[180:183], v[48:63]
    ds_read_b64_tr_b16 v[80:81], v11 offset:0
    ds_read_b64_tr_b16 v[82:83], v11 offset:256
    v_fma_f32 v79, -v47, s48, v121
    v_fma_f32 v47, v47, s48, v120
    v_exp_f32 v78, v78
    s_waitcnt lgkmcnt(4)
    v_mfma_f32_32x32x16_bf16 v[48:63], v[88:91], v[184:187], v[48:63]
    ds_read_b64_tr_b16 v[84:85], v11 offset:4096
    ds_read_b64_tr_b16 v[86:87], v11 offset:4352
    v_exp_f32 v46, v46
    v_add_f32 v124, v124, v45
    v_add_f32 v125, v125, v77
    s_waitcnt lgkmcnt(4)
    v_mfma_f32_32x32x16_bf16 v[48:63], v[92:95], v[188:191], v[48:63]
    ds_read_b64_tr_b16 v[88:89], v11 offset:8192
    ds_read_b64_tr_b16 v[90:91], v11 offset:8448
    v_exp_f32 v79, v79
    v_exp_f32 v47, v47
    s_waitcnt lgkmcnt(4)
    v_mfma_f32_32x32x16_bf16 v[48:63], v[80:83], v[192:195], v[48:63]
    ds_read_b64_tr_b16 v[92:93], v11 offset:12288
    ds_read_b64_tr_b16 v[94:95], v11 offset:12544
    buffer_load_dwordx4 v[104:107], v4, s[24:27], s64 offen
    v_add_f32 v124, v124, v46
    v_add_f32 v125, v125, v78
    v_add_f32 v125, v125, v79
    v_add_f32 v124, v124, v47
    s_waitcnt lgkmcnt(4)
    v_mfma_f32_32x32x16_bf16 v[48:63], v[84:87], v[196:199], v[48:63]
    ds_read_b64_tr_b16 v[80:81], v11 offset:1024
    ds_read_b64_tr_b16 v[82:83], v11 offset:1280
    v_rcp_f32 v125, v125
    v_rcp_f32 v124, v124
    s_waitcnt lgkmcnt(4)
    v_mfma_f32_32x32x16_bf16 v[48:63], v[88:91], v[200:203], v[48:63]
    ds_read_b64_tr_b16 v[84:85], v11 offset:5120
    ds_read_b64_tr_b16 v[86:87], v11 offset:5376
    v_mul_f32 v64, v64, v125
    v_mul_f32 v65, v65, v125
    v_cvt_pk_bf16_f32 v64, v64, v65
    v_mul_f32 v66, v66, v125
    s_waitcnt lgkmcnt(4)
    v_mfma_f32_32x32x16_bf16 v[48:63], v[92:95], v[204:207], v[48:63]
    ds_read_b64_tr_b16 v[88:89], v11 offset:9216
    ds_read_b64_tr_b16 v[90:91], v11 offset:9472
    v_mul_f32 v67, v67, v125
    v_cvt_pk_bf16_f32 v65, v66, v67
    v_mul_f32 v68, v68, v125
    v_mul_f32 v69, v69, v125
    s_waitcnt lgkmcnt(4)
    v_mfma_f32_32x32x16_bf16 v[48:63], v[80:83], v[208:211], v[48:63]
    ds_read_b64_tr_b16 v[92:93], v11 offset:13312
    ds_read_b64_tr_b16 v[94:95], v11 offset:13568
    buffer_load_dwordx4 v[108:111], v4, s[24:27], s65 offen
    v_cvt_pk_bf16_f32 v66, v68, v69
    v_mul_f32 v70, v70, v125
    v_mul_f32 v71, v71, v125
    v_cvt_pk_bf16_f32 v67, v70, v71
    s_waitcnt lgkmcnt(4)
    v_mfma_f32_32x32x16_bf16 v[48:63], v[84:87], v[212:215], v[48:63]
    ds_read_b64_tr_b16 v[80:81], v11 offset:2048
    ds_read_b64_tr_b16 v[82:83], v11 offset:2304
    v_mul_f32 v72, v72, v125
    v_mul_f32 v73, v73, v125
    v_cvt_pk_bf16_f32 v68, v72, v73
    v_mul_f32 v74, v74, v125
    s_waitcnt lgkmcnt(4)
    v_mfma_f32_32x32x16_bf16 v[48:63], v[88:91], v[216:219], v[48:63]
    ds_read_b64_tr_b16 v[84:85], v11 offset:6144
    ds_read_b64_tr_b16 v[86:87], v11 offset:6400
    v_mul_f32 v75, v75, v125
    v_cvt_pk_bf16_f32 v69, v74, v75
    v_mul_f32 v76, v76, v125
    v_mul_f32 v77, v77, v125
    s_waitcnt lgkmcnt(4)
    v_mfma_f32_32x32x16_bf16 v[48:63], v[92:95], v[220:223], v[48:63]
    ds_read_b64_tr_b16 v[88:89], v11 offset:10240
    ds_read_b64_tr_b16 v[90:91], v11 offset:10496
    v_cvt_pk_bf16_f32 v70, v76, v77
    v_mul_f32 v78, v78, v125
    v_mul_f32 v79, v79, v125
    v_cvt_pk_bf16_f32 v71, v78, v79
    s_waitcnt lgkmcnt(4)
    v_mfma_f32_32x32x16_bf16 v[48:63], v[80:83], v[224:227], v[48:63]
    ds_read_b64_tr_b16 v[92:93], v11 offset:14336
    ds_read_b64_tr_b16 v[94:95], v11 offset:14592
    buffer_load_dwordx4 v[112:115], v4, s[24:27], s66 offen
    v_mul_f32 v32, v32, v124
    v_mul_f32 v33, v33, v124
    v_cvt_pk_bf16_f32 v32, v32, v33
    v_mul_f32 v34, v34, v124
    s_waitcnt lgkmcnt(4)
    v_mfma_f32_32x32x16_bf16 v[48:63], v[84:87], v[228:231], v[48:63]
    ds_read_b64_tr_b16 v[80:81], v11 offset:3072
    ds_read_b64_tr_b16 v[82:83], v11 offset:3328
    v_mul_f32 v35, v35, v124
    v_cvt_pk_bf16_f32 v33, v34, v35
    v_mul_f32 v36, v36, v124
    v_mul_f32 v37, v37, v124
    s_waitcnt lgkmcnt(4)
    v_mfma_f32_32x32x16_bf16 v[48:63], v[88:91], v[232:235], v[48:63]
    ds_read_b64_tr_b16 v[84:85], v11 offset:7168
    ds_read_b64_tr_b16 v[86:87], v11 offset:7424
    v_cvt_pk_bf16_f32 v34, v36, v37
    v_mul_f32 v38, v38, v124
    v_mul_f32 v39, v39, v124
    v_cvt_pk_bf16_f32 v35, v38, v39
    s_waitcnt lgkmcnt(4)
    v_mfma_f32_32x32x16_bf16 v[48:63], v[92:95], v[236:239], v[48:63]
    ds_read_b64_tr_b16 v[88:89], v11 offset:11264
    ds_read_b64_tr_b16 v[90:91], v11 offset:11520
    v_mul_f32 v40, v40, v124
    v_mul_f32 v41, v41, v124
    v_cvt_pk_bf16_f32 v36, v40, v41
    v_mul_f32 v42, v42, v124
    s_waitcnt lgkmcnt(4)
    v_mfma_f32_32x32x16_bf16 v[48:63], v[80:83], v[240:243], v[48:63]
    ds_read_b64_tr_b16 v[92:93], v11 offset:15360
    ds_read_b64_tr_b16 v[94:95], v11 offset:15616
    buffer_load_dwordx4 v[116:119], v4, s[24:27], s67 offen
    v_mul_f32 v43, v43, v124
    v_cvt_pk_bf16_f32 v37, v42, v43
    v_mul_f32 v44, v44, v124
    v_mul_f32 v45, v45, v124
    s_waitcnt lgkmcnt(4)
    v_mfma_f32_32x32x16_bf16 v[48:63], v[84:87], v[244:247], v[48:63]
    v_cvt_pk_bf16_f32 v38, v44, v45
    v_mul_f32 v46, v46, v124
    v_mul_f32 v47, v47, v124
    v_cvt_pk_bf16_f32 v39, v46, v47
    s_waitcnt lgkmcnt(2)
    v_mfma_f32_32x32x16_bf16 v[48:63], v[88:91], v[248:251], v[48:63]
    s_waitcnt lgkmcnt(0)
    v_mfma_f32_32x32x16_bf16 v[48:63], v[92:95], v[252:255], v[48:63]
    ds_write_b128 v15, v[64:67] offset:32
    ds_write_b128 v15, v[68:71] offset:48
    ds_write_b128 v15, v[32:35] offset:0
    ds_write_b128 v15, v[36:39] offset:16
    s_nop 7
    v_cvt_pk_bf16_f32 v80, v48, v49
    v_cvt_pk_bf16_f32 v81, v50, v51
    v_cvt_pk_bf16_f32 v82, v52, v53
    v_cvt_pk_bf16_f32 v83, v54, v55
    ds_write_b128 v16, v[80:83]
    v_cvt_pk_bf16_f32 v84, v56, v57
    v_cvt_pk_bf16_f32 v85, v58, v59
    v_cvt_pk_bf16_f32 v86, v60, v61
    v_cvt_pk_bf16_f32 v87, v62, v63
    ds_write_b128 v16, v[84:87] offset:16
    v_mov_b32 v120, 0x3f803f80
    v_mov_b32 v121, 0x3f803f80
    v_mov_b32 v122, 0x3f803f80
    v_mov_b32 v123, 0x3f803f80
    s_lshl_b32 s40, s38, 9
    s_add_u32 s40, s40, 802816
    v_lshl_add_u32 v5, v1, 3, s40
    v_lshl_add_u32 v8, v26, 3, s9
    s_waitcnt vmcnt(4) lgkmcnt(0)
    s_barrier
    ds_read_b64_tr_b16 v[64:65], v17 offset:0
    ds_read_b64_tr_b16 v[66:67], v17 offset:3584
    ds_read_b64_tr_b16 v[68:69], v18 offset:0
    ds_read_b64_tr_b16 v[70:71], v18 offset:3584
    ds_read_b64_tr_b16 v[72:73], v17 offset:7168
    ds_read_b64_tr_b16 v[74:75], v17 offset:10752
    ds_read_b64_tr_b16 v[76:77], v18 offset:7168
    ds_read_b64_tr_b16 v[78:79], v18 offset:10752
    ds_read_b64_tr_b16 v[80:81], v17 offset:14336
    ds_read_b64_tr_b16 v[82:83], v17 offset:17920
    ds_read_b64_tr_b16 v[84:85], v18 offset:14336
    ds_read_b64_tr_b16 v[86:87], v18 offset:17920
    ds_read_b64_tr_b16 v[88:89], v17 offset:21504
    ds_read_b64_tr_b16 v[90:91], v17 offset:25088
    ds_read_b64_tr_b16 v[92:93], v18 offset:21504
    ds_read_b64_tr_b16 v[94:95], v18 offset:25088
    s_waitcnt lgkmcnt(14)
    v_mfma_f32_16x16x32_bf16 v[36:39], v[64:67], v[120:123], 0
    s_waitcnt lgkmcnt(12)
    v_mfma_f32_16x16x32_bf16 v[32:35], v[64:67], v[68:71], 0
    s_waitcnt lgkmcnt(10)
    v_mfma_f32_16x16x32_bf16 v[36:39], v[72:75], v[120:123], v[36:39]
    s_waitcnt lgkmcnt(8)
    v_mfma_f32_16x16x32_bf16 v[32:35], v[72:75], v[76:79], v[32:35]
    s_waitcnt lgkmcnt(6)
    v_mfma_f32_16x16x32_bf16 v[36:39], v[80:83], v[120:123], v[36:39]
    s_waitcnt lgkmcnt(4)
    v_mfma_f32_16x16x32_bf16 v[32:35], v[80:83], v[84:87], v[32:35]
    s_waitcnt lgkmcnt(2)
    v_mfma_f32_16x16x32_bf16 v[36:39], v[88:91], v[120:123], v[36:39]
    s_waitcnt lgkmcnt(0)
    v_mfma_f32_16x16x32_bf16 v[32:35], v[88:91], v[92:95], v[32:35]
    s_add_u32 s40, s44, 65536
    v_lshl_add_u32 v30, v1, 4, s40
    s_nop 3
    v_cvt_pk_bf16_f32 v50, v36, v37
    v_cvt_pk_bf16_f32 v51, v38, v39
    v_cvt_pk_bf16_f32 v48, v32, v33
    v_cvt_pk_bf16_f32 v49, v34, v35
    v_min_u32 v50, -2, v50
    v_min_u32 v51, -2, v51
    v_min_u32 v48, -2, v48
    v_min_u32 v49, -2, v49
    global_store_dwordx2 v19, v[48:49], s[18:19] sc1
    s_mov_b64 exec, s[50:51]
    global_store_dwordx2 v20, v[50:51], s[18:19] sc1
    s_mov_b64 exec, -1
    global_load_dwordx2 v[28:29], v5, s[18:19] sc1
    s_lshl_b32 s40, s14, 8
    s_lshr_b32 s41, s36, 1
    s_lshl_b32 s41, s41, 7
    s_add_u32 s40, s40, s41
    s_add_u32 s40, s40, 819200
    v_mov_b32 v9, s40
    global_load_dword v31, v9, s[18:19]
    global_load_dword v31, v14, s[18:19]
    global_load_dword v31, v14, s[18:19] offset:256
    s_waitcnt vmcnt(6)
    ds_write_b128 v30, v[104:107] offset:0
    ds_write_b128 v30, v[108:111] offset:1024
    ds_write_b128 v30, v[112:115] offset:2048
    ds_write_b128 v30, v[116:119] offset:3072
    ds_read_b64_tr_b16 v[64:65], v11 offset:16384
    ds_read_b64_tr_b16 v[66:67], v11 offset:16640
    ds_read_b64_tr_b16 v[68:69], v11 offset:20480
    ds_read_b64_tr_b16 v[70:71], v11 offset:20736
    ds_read_b64_tr_b16 v[72:73], v11 offset:24576
    ds_read_b64_tr_b16 v[74:75], v11 offset:24832
    ds_read_b64_tr_b16 v[76:77], v11 offset:28672
    ds_read_b64_tr_b16 v[78:79], v11 offset:28928
    s_mul_i32 s72, s36, 4
    s_add_u32 s72, s72, 32
    s_lshl_b32 s73, s72, 13
    s_lshl_b32 s72, s72, 10
    s_add_u32 m0, s72, 0
    s_nop 0
    buffer_load_dwordx4 v12, s[28:31], s73 offen lds
    s_add_u32 s73, s73, 8192
    ds_read_b64_tr_b16 v[80:81], v11 offset:17408
    ds_read_b64_tr_b16 v[82:83], v11 offset:17664
    s_waitcnt lgkmcnt(8)
    v_mfma_f32_32x32x16_bf16 v[32:47], v[64:67], v[128:131], 0
    ds_read_b64_tr_b16 v[84:85], v11 offset:21504
    ds_read_b64_tr_b16 v[86:87], v11 offset:21760
    s_waitcnt lgkmcnt(8)
    v_mfma_f32_32x32x16_bf16 v[32:47], v[68:71], v[132:135], v[32:47]
    ds_read_b64_tr_b16 v[88:89], v11 offset:25600
    ds_read_b64_tr_b16 v[90:91], v11 offset:25856
    s_waitcnt lgkmcnt(8)
    v_mfma_f32_32x32x16_bf16 v[32:47], v[72:75], v[136:139], v[32:47]
    s_add_u32 m0, s72, 1024
    s_nop 0
    buffer_load_dwordx4 v13, s[28:31], s73 offen lds
    s_add_u32 s73, s73, 8192
    ds_read_b64_tr_b16 v[92:93], v11 offset:29696
    ds_read_b64_tr_b16 v[94:95], v11 offset:29952
    s_waitcnt lgkmcnt(8)
    v_mfma_f32_32x32x16_bf16 v[32:47], v[76:79], v[140:143], v[32:47]
    ds_read_b64_tr_b16 v[64:65], v11 offset:18432
    ds_read_b64_tr_b16 v[66:67], v11 offset:18688
    s_waitcnt lgkmcnt(8)
    v_mfma_f32_32x32x16_bf16 v[32:47], v[80:83], v[144:147], v[32:47]
    s_lshl_b32 s40, s38, 2
    s_add_u32 s40, s40, s36
    s_mul_i32 s40, s40, 12288
    ds_read_b64_tr_b16 v[68:69], v11 offset:22528
    ds_read_b64_tr_b16 v[70:71], v11 offset:22784
    s_waitcnt lgkmcnt(8)
    v_mfma_f32_32x32x16_bf16 v[32:47], v[84:87], v[148:151], v[32:47]
    s_add_u32 s40, s40, 0
    v_lshl_add_u32 v21, v1, 4, s40
    v_add_u32 v22, 0x1000, v21
    ds_read_b64_tr_b16 v[72:73], v11 offset:26624
    ds_read_b64_tr_b16 v[74:75], v11 offset:26880
    s_waitcnt lgkmcnt(8)
    v_mfma_f32_32x32x16_bf16 v[32:47], v[88:91], v[152:155], v[32:47]
    s_add_u32 m0, s72, 2048
    s_nop 0
    buffer_load_dwordx4 v12, s[28:31], s73 offen lds
    s_add_u32 s73, s73, 8192
    v_add_u32 v23, 0x2000, v21
    v_and_b32 v6, 1, v1
    v_lshlrev_b32 v6, 4, v6
    ds_read_b64_tr_b16 v[76:77], v11 offset:30720
    ds_read_b64_tr_b16 v[78:79], v11 offset:30976
    s_waitcnt lgkmcnt(8)
    v_mfma_f32_32x32x16_bf16 v[32:47], v[92:95], v[156:159], v[32:47]
    v_mov_b32 v7, 0x3f80
    v_lshlrev_b32 v7, v6, v7
    v_lshrrev_b32 v6, 1, v27
    ds_read_b64_tr_b16 v[80:81], v11 offset:19456
    ds_read_b64_tr_b16 v[82:83], v11 offset:19712
    s_waitcnt lgkmcnt(8)
    v_mfma_f32_32x32x16_bf16 v[32:47], v[64:67], v[160:163], v[32:47]
    v_cmp_eq_u32 vcc, 0, v6
    s_nop 1
    v_cndmask_b32 v116, 0, v7, vcc
    v_cmp_eq_u32 vcc, 1, v6
    ds_read_b64_tr_b16 v[84:85], v11 offset:23552
    ds_read_b64_tr_b16 v[86:87], v11 offset:23808
    s_waitcnt lgkmcnt(8)
    v_mfma_f32_32x32x16_bf16 v[32:47], v[68:71], v[164:167], v[32:47]
    v_cndmask_b32 v117, 0, v7, vcc
    v_cmp_eq_u32 vcc, 2, v6
    s_nop 1
    v_cndmask_b32 v118, 0, v7, vcc
    ds_read_b64_tr_b16 v[88:89], v11 offset:27648
    ds_read_b64_tr_b16 v[90:91], v11 offset:27904
    s_waitcnt lgkmcnt(8)
    v_mfma_f32_32x32x16_bf16 v[32:47], v[72:75], v[168:171], v[32:47]
    s_add_u32 m0, s72, 3072
    s_nop 0
    buffer_load_dwordx4 v13, s[28:31], s73 offen lds
    v_cmp_eq_u32 vcc, 3, v6
    s_nop 1
    v_cndmask_b32 v119, 0, v7, vcc
    v_lshrrev_b32 v6, 4, v1
    ds_read_b64_tr_b16 v[92:93], v11 offset:31744
    ds_read_b64_tr_b16 v[94:95], v11 offset:32000
    s_waitcnt lgkmcnt(8)
    v_mfma_f32_32x32x16_bf16 v[32:47], v[76:79], v[172:175], v[32:47]
    v_mul_u32_u24 v17, 48, v25
    v_add_u32 v17, v17, v27
    v_mul_u32_u24 v17, 80, v17
    s_waitcnt lgkmcnt(6)
    v_mfma_f32_32x32x16_bf16 v[32:47], v[80:83], v[176:179], v[32:47]
    v_and_b32 v6, 1, v6
    v_lshl_add_u32 v17, v6, 3, v17
    s_lshl_b32 s40, s36, 4
    s_waitcnt lgkmcnt(4)
    v_mfma_f32_32x32x16_bf16 v[32:47], v[84:87], v[180:183], v[32:47]
    s_add_u32 s40, s40, 65536
    v_add_u32 v17, s40, v17
    v_lshrrev_b32 v6, 3, v26
    s_waitcnt lgkmcnt(2)
    v_mfma_f32_32x32x16_bf16 v[32:47], v[88:91], v[184:187], v[32:47]
    v_and_b32 v7, 3, v1
    v_lshl_add_u32 v6, v6, 2, v7
    v_lshl_add_u32 v6, v25, 4, v6
    s_waitcnt lgkmcnt(0)
    v_mfma_f32_32x32x16_bf16 v[32:47], v[92:95], v[188:191], v[32:47]
    v_add_u32 v7, 48, v27
    v_cndmask_b32_e64 v18, v7, v6, s[46:47]
    v_add_u32 v6, 32, v25
    s_barrier
    ds_read_b64_tr_b16 v[64:65], v11 offset:32768
    ds_read_b64_tr_b16 v[66:67], v11 offset:33024
    ds_read_b64_tr_b16 v[68:69], v11 offset:36864
    ds_read_b64_tr_b16 v[70:71], v11 offset:37120
    ds_read_b64_tr_b16 v[72:73], v11 offset:40960
    ds_read_b64_tr_b16 v[74:75], v11 offset:41216
    ds_read_b64_tr_b16 v[76:77], v11 offset:45056
    ds_read_b64_tr_b16 v[78:79], v11 offset:45312
    s_mul_i32 s72, s36, 8
    s_add_u32 s72, s72, 0
    s_lshl_b32 s73, s72, 13
    s_lshl_b32 s72, s72, 10
    s_add_u32 m0, s72, 0
    s_nop 0
    buffer_load_dwordx4 v12, s[28:31], s73 offen lds
    s_add_u32 s73, s73, 8192
    ds_read_b64_tr_b16 v[80:81], v11 offset:33792
    ds_read_b64_tr_b16 v[82:83], v11 offset:34048
    s_waitcnt lgkmcnt(8)
    v_mfma_f32_32x32x16_bf16 v[32:47], v[64:67], v[192:195], v[32:47]
    s_add_u32 m0, s72, 1024
    s_nop 0
    buffer_load_dwordx4 v13, s[28:31], s73 offen lds
    s_add_u32 s73, s73, 8192
    v_cndmask_b32_e64 v19, v7, v6, s[46:47]
    v_mul_u32_u24 v18, 80, v18
    v_mul_u32_u24 v19, 80, v19
    ds_read_b64_tr_b16 v[84:85], v11 offset:37888
    ds_read_b64_tr_b16 v[86:87], v11 offset:38144
    s_waitcnt lgkmcnt(8)
    v_mfma_f32_32x32x16_bf16 v[32:47], v[68:71], v[196:199], v[32:47]
    v_add_u32 v18, 65536, v18
    v_add_u32 v19, 65536, v19
    v_lshrrev_b32 v6, 4, v1
    ds_read_b64_tr_b16 v[88:89], v11 offset:41984
    ds_read_b64_tr_b16 v[90:91], v11 offset:42240
    s_waitcnt lgkmcnt(8)
    v_mfma_f32_32x32x16_bf16 v[32:47], v[72:75], v[200:203], v[32:47]
    s_add_u32 m0, s72, 2048
    s_nop 0
    buffer_load_dwordx4 v12, s[28:31], s73 offen lds
    s_add_u32 s73, s73, 8192
    v_bfe_u32 v7, v1, 2, 2
    v_lshl_add_u32 v2, v6, 3, v7
    v_lshlrev_b32 v2, 7, v2
    ds_read_b64_tr_b16 v[92:93], v11 offset:46080
    ds_read_b64_tr_b16 v[94:95], v11 offset:46336
    s_waitcnt lgkmcnt(8)
    v_mfma_f32_32x32x16_bf16 v[32:47], v[76:79], v[204:207], v[32:47]
    v_lshrrev_b32 v7, 1, v7
    v_and_b32 v9, 3, v1
    v_xor_b32 v7, v7, v9
    ds_read_b64_tr_b16 v[64:65], v11 offset:34816
    ds_read_b64_tr_b16 v[66:67], v11 offset:35072
    s_waitcnt lgkmcnt(8)
    v_mfma_f32_32x32x16_bf16 v[32:47], v[80:83], v[208:211], v[32:47]
    s_add_u32 m0, s72, 3072
    s_nop 0
    buffer_load_dwordx4 v13, s[28:31], s73 offen lds
    s_add_u32 s73, s73, 8192
    v_lshl_add_u32 v2, v7, 4, v2
    v_and_b32 v7, 1, v6
    v_lshl_add_u32 v2, v7, 6, v2
    ds_read_b64_tr_b16 v[68:69], v11 offset:38912
    ds_read_b64_tr_b16 v[70:71], v11 offset:39168
    s_waitcnt lgkmcnt(8)
    v_mfma_f32_32x32x16_bf16 v[32:47], v[84:87], v[212:215], v[32:47]
    v_cmp_eq_u32_e64 s[78:79], 1, v7
    v_and_b32 v7, 1, v9
    v_lshl_add_u32 v2, v7, 3, v2
    ds_read_b64_tr_b16 v[72:73], v11 offset:43008
    ds_read_b64_tr_b16 v[74:75], v11 offset:43264
    s_waitcnt lgkmcnt(8)
    v_mfma_f32_32x32x16_bf16 v[32:47], v[88:91], v[216:219], v[32:47]
    v_xor_b32 v3, 8, v2
    v_xor_b32 v4, 64, v2
    ds_read_b64_tr_b16 v[76:77], v11 offset:47104
    ds_read_b64_tr_b16 v[78:79], v11 offset:47360
    s_waitcnt lgkmcnt(8)
    v_mfma_f32_32x32x16_bf16 v[32:47], v[92:95], v[220:223], v[32:47]
    ds_read_b64_tr_b16 v[80:81], v11 offset:35840
    ds_read_b64_tr_b16 v[82:83], v11 offset:36096
    s_waitcnt lgkmcnt(8)
    v_mfma_f32_32x32x16_bf16 v[32:47], v[64:67], v[224:227], v[32:47]
    ds_read_b64_tr_b16 v[84:85], v11 offset:39936
    ds_read_b64_tr_b16 v[86:87], v11 offset:40192
    s_waitcnt lgkmcnt(8)
    v_mfma_f32_32x32x16_bf16 v[32:47], v[68:71], v[228:231], v[32:47]
    ds_read_b64_tr_b16 v[88:89], v11 offset:44032
    ds_read_b64_tr_b16 v[90:91], v11 offset:44288
    s_waitcnt lgkmcnt(8)
    v_mfma_f32_32x32x16_bf16 v[32:47], v[72:75], v[232:235], v[32:47]
    ds_read_b64_tr_b16 v[92:93], v11 offset:48128
    ds_read_b64_tr_b16 v[94:95], v11 offset:48384
    s_waitcnt lgkmcnt(8)
    v_mfma_f32_32x32x16_bf16 v[32:47], v[76:79], v[236:239], v[32:47]
    s_waitcnt lgkmcnt(6)
    v_mfma_f32_32x32x16_bf16 v[32:47], v[80:83], v[240:243], v[32:47]
    s_waitcnt lgkmcnt(4)
    v_mfma_f32_32x32x16_bf16 v[32:47], v[84:87], v[244:247], v[32:47]
    s_waitcnt lgkmcnt(2)
    v_mfma_f32_32x32x16_bf16 v[32:47], v[88:91], v[248:251], v[32:47]
    s_waitcnt lgkmcnt(0)
    v_mfma_f32_32x32x16_bf16 v[32:47], v[92:95], v[252:255], v[32:47]
    s_barrier
    s_mov_b32 s77, 0x40000
    s_waitcnt vmcnt(11)
.Aflag_4:
    v_cmp_ne_u64 vcc, s[4:5], v[28:29]
    s_cbranch_vccz .Aflagdone_5
    s_sub_u32 s77, s77, 1
    s_cbranch_scc1 .Aflagdone_5
    s_sleep 4
    global_load_dwordx2 v[28:29], v5, s[18:19] sc1
    s_waitcnt vmcnt(0)
    s_branch .Aflag_4
.Aflagdone_5:
    s_nop 0
    v_cvt_pk_bf16_f32 v120, v32, v33
    v_cvt_pk_bf16_f32 v121, v34, v35
    v_cvt_pk_bf16_f32 v122, v36, v37
    v_cvt_pk_bf16_f32 v123, v38, v39
    v_cvt_pk_bf16_f32 v124, v40, v41
    v_cvt_pk_bf16_f32 v125, v42, v43
    v_cvt_pk_bf16_f32 v126, v44, v45
    v_cvt_pk_bf16_f32 v127, v46, v47
    v_mfma_f32_32x32x16_bf16 v[48:63], v[96:99], v[120:123], 0
    s_nop 0
    v_mfma_f32_32x32x16_bf16 v[48:63], v[100:103], v[124:127], v[48:63]
    global_load_dwordx4 v[144:147], v21, s[18:19] offset:0 sc1
    global_load_dwordx4 v[148:151], v21, s[18:19] offset:1024 sc1
    global_load_dwordx4 v[152:155], v21, s[18:19] offset:2048 sc1
    global_load_dwordx4 v[156:159], v21, s[18:19] offset:3072 sc1
    global_load_dwordx4 v[160:163], v22, s[18:19] offset:0 sc1
    global_load_dwordx4 v[164:167], v22, s[18:19] offset:1024 sc1
    v_xor_b32 v5, 0x48, v2
    global_load_dwordx4 v[168:171], v22, s[18:19] offset:2048 sc1
    s_nop 3
    v_max3_f32 v120, v48, v49, v50
    v_min3_f32 v121, v48, v49, v50
    v_max3_f32 v122, v51, v52, v53
    global_load_dwordx4 v[172:175], v22, s[18:19] offset:3072 sc1
    v_min3_f32 v123, v51, v52, v53
    v_max3_f32 v120, v120, v54, v55
    v_min3_f32 v121, v121, v54, v55
    global_load_dwordx4 v[176:179], v23, s[18:19] offset:0 sc1
    v_max3_f32 v122, v122, v56, v57
    v_min3_f32 v123, v123, v56, v57
    v_max3_f32 v120, v120, v58, v59
    global_load_dwordx4 v[180:183], v23, s[18:19] offset:1024 sc1
    v_min3_f32 v121, v121, v58, v59
    v_max3_f32 v122, v122, v60, v61
    v_min3_f32 v123, v123, v60, v61
    global_load_dwordx4 v[184:187], v23, s[18:19] offset:2048 sc1
    v_max3_f32 v120, v120, v62, v63
    v_min3_f32 v121, v121, v62, v63
    v_max_f32 v120, v120, v122
    global_load_dwordx4 v[188:191], v23, s[18:19] offset:3072 sc1
    v_min_f32 v121, v121, v123
    v_mul_f32_e64 v120, -v120, s48
    v_mul_f32 v121, s48, v121
    global_load_dwordx2 v[6:7], v8, s[18:19] sc1
    v_fma_f32 v64, -v48, s48, v121
    v_fma_f32 v48, v48, s48, v120
    v_fma_f32 v65, -v49, s48, v121
    v_fma_f32 v49, v49, s48, v120
    v_exp_f32 v64, v64
    v_exp_f32 v48, v48
    v_fma_f32 v66, -v50, s48, v121
    v_fma_f32 v50, v50, s48, v120
    v_exp_f32 v65, v65
    v_exp_f32 v49, v49
    v_fma_f32 v67, -v51, s48, v121
    v_fma_f32 v51, v51, s48, v120
    v_exp_f32 v66, v66
    v_exp_f32 v50, v50
    v_add_f32 v124, v48, v49
    v_add_f32 v125, v64, v65
    v_fma_f32 v68, -v52, s48, v121
    v_fma_f32 v52, v52, s48, v120
    v_exp_f32 v67, v67
    v_exp_f32 v51, v51
    v_add_f32 v124, v124, v50
    v_add_f32 v125, v125, v66
    v_fma_f32 v69, -v53, s48, v121
    v_fma_f32 v53, v53, s48, v120
    v_exp_f32 v68, v68
    s_add_u32 m0, s72, 4096
    s_nop 0
    buffer_load_dwordx4 v12, s[28:31], s73 offen lds
    s_add_u32 s73, s73, 8192
    v_exp_f32 v52, v52
    v_add_f32 v124, v124, v51
    v_add_f32 v125, v125, v67
    v_fma_f32 v70, -v54, s48, v121
    v_fma_f32 v54, v54, s48, v120
    v_exp_f32 v69, v69
    v_exp_f32 v53, v53
    v_add_f32 v124, v124, v52
    v_add_f32 v125, v125, v68
    v_fma_f32 v71, -v55, s48, v121
    v_fma_f32 v55, v55, s48, v120
    v_exp_f32 v70, v70
    v_exp_f32 v54, v54
    s_add_u32 m0, s72, 5120
    s_nop 0
    buffer_load_dwordx4 v13, s[28:31], s73 offen lds
    s_add_u32 s73, s73, 8192
    v_add_f32 v124, v124, v53
    v_add_f32 v125, v125, v69
    v_fma_f32 v72, -v56, s48, v121
    v_fma_f32 v56, v56, s48, v120
    v_exp_f32 v71, v71
    v_exp_f32 v55, v55
    v_add_f32 v124, v124, v54
    v_add_f32 v125, v125, v70
    v_fma_f32 v73, -v57, s48, v121
    v_fma_f32 v57, v57, s48, v120
    v_exp_f32 v72, v72
    v_exp_f32 v56, v56
    v_add_f32 v124, v124, v55
    s_add_u32 m0, s72, 6144
    s_nop 0
    buffer_load_dwordx4 v12, s[28:31], s73 offen lds
    s_add_u32 s73, s73, 8192
    v_add_f32 v125, v125, v71
    v_fma_f32 v74, -v58, s48, v121
    v_fma_f32 v58, v58, s48, v120
    v_exp_f32 v73, v73
    v_exp_f32 v57, v57
    v_add_f32 v124, v124, v56
    v_add_f32 v125, v125, v72
    v_fma_f32 v75, -v59, s48, v121
    v_fma_f32 v59, v59, s48, v120
    v_exp_f32 v74, v74
    v_exp_f32 v58, v58
    v_add_f32 v124, v124, v57
    v_add_f32 v125, v125, v73
    s_add_u32 m0, s72, 7168
    s_nop 0
    buffer_load_dwordx4 v13, s[28:31], s73 offen lds
    v_fma_f32 v76, -v60, s48, v121
    v_fma_f32 v60, v60, s48, v120
    v_exp_f32 v75, v75
    v_exp_f32 v59, v59
    v_add_f32 v124, v124, v58
    v_add_f32 v125, v125, v74
    v_fma_f32 v77, -v61, s48, v121
    v_fma_f32 v61, v61, s48, v120
    v_exp_f32 v76, v76
    v_exp_f32 v60, v60
    v_add_f32 v124, v124, v59
    v_add_f32 v125, v125, v75
    v_fma_f32 v78, -v62, s48, v121
    s_mul_i32 s72, s36, 4
    s_add_u32 s72, s72, 48
    s_lshl_b32 s73, s72, 13
    s_lshl_b32 s72, s72, 10
    s_add_u32 m0, s72, 0
    s_nop 0
    buffer_load_dwordx4 v12, s[28:31], s73 offen lds
    s_add_u32 s73, s73, 8192
    v_fma_f32 v62, v62, s48, v120
    v_exp_f32 v77, v77
    v_exp_f32 v61, v61
    v_add_f32 v124, v124, v60
    v_add_f32 v125, v125, v76
    v_fma_f32 v79, -v63, s48, v121
    v_fma_f32 v63, v63, s48, v120
    v_exp_f32 v78, v78
    v_exp_f32 v62, v62
    v_add_f32 v124, v124, v61
    v_add_f32 v125, v125, v77
    v_exp_f32 v79, v79
    v_exp_f32 v63, v63
    s_add_u32 m0, s72, 1024
    s_nop 0
    buffer_load_dwordx4 v13, s[28:31], s73 offen lds
    s_add_u32 s73, s73, 8192
    v_add_f32 v124, v124, v62
    v_add_f32 v125, v125, v78
    v_add_f32 v125, v125, v79
    v_add_f32 v124, v124, v63
    v_rcp_f32 v125, v125
    v_rcp_f32 v124, v124
    v_mul_f32 v64, v64, v125
    v_mul_f32 v65, v65, v125
    v_cvt_pk_bf16_f32 v136, v64, v65
    v_mul_f32 v66, v66, v125
    v_mul_f32 v67, v67, v125
    v_cvt_pk_bf16_f32 v137, v66, v67
    v_mul_f32 v68, v68, v125
    s_add_u32 m0, s72, 2048
    s_nop 0
    buffer_load_dwordx4 v12, s[28:31], s73 offen lds
    s_add_u32 s73, s73, 8192
    v_mul_f32 v69, v69, v125
    v_cvt_pk_bf16_f32 v138, v68, v69
    v_mul_f32 v70, v70, v125
    v_mul_f32 v71, v71, v125
    v_cvt_pk_bf16_f32 v139, v70, v71
    v_mul_f32 v72, v72, v125
    v_mul_f32 v73, v73, v125
    v_cvt_pk_bf16_f32 v140, v72, v73
    v_mul_f32 v74, v74, v125
    v_mul_f32 v75, v75, v125
    v_cvt_pk_bf16_f32 v141, v74, v75
    v_mul_f32 v76, v76, v125
    v_mul_f32 v77, v77, v125
    s_add_u32 m0, s72, 3072
    s_nop 0
    buffer_load_dwordx4 v13, s[28:31], s73 offen lds
    v_cvt_pk_bf16_f32 v142, v76, v77
    v_mul_f32 v78, v78, v125
    v_mul_f32 v79, v79, v125
    v_cvt_pk_bf16_f32 v143, v78, v79
    v_mul_f32 v48, v48, v124
    v_mul_f32 v49, v49, v124
    v_cvt_pk_bf16_f32 v128, v48, v49
    v_mul_f32 v50, v50, v124
    v_mul_f32 v51, v51, v124
    v_cvt_pk_bf16_f32 v129, v50, v51
    v_mul_f32 v52, v52, v124
    v_mul_f32 v53, v53, v124
    v_cvt_pk_bf16_f32 v130, v52, v53
    v_mul_f32 v54, v54, v124
    v_mul_f32 v55, v55, v124
    v_cvt_pk_bf16_f32 v131, v54, v55
    v_mul_f32 v56, v56, v124
    v_mul_f32 v57, v57, v124
    v_cvt_pk_bf16_f32 v132, v56, v57
    v_mul_f32 v58, v58, v124
    v_mul_f32 v59, v59, v124
    v_cvt_pk_bf16_f32 v133, v58, v59
    v_mul_f32 v60, v60, v124
    v_mul_f32 v61, v61, v124
    v_cvt_pk_bf16_f32 v134, v60, v61
    v_mul_f32 v62, v62, v124
    v_mul_f32 v63, v63, v124
    v_cvt_pk_bf16_f32 v135, v62, v63
    s_mov_b32 s77, 0x10000
    s_waitcnt vmcnt(8)
    v_mfma_f32_16x16x32_bf16 v[32:35], v[116:119], v[144:147], 0
    v_max3_u32 v120, v144, v145, v146
    v_mfma_f32_16x16x32_bf16 v[36:39], v[116:119], v[160:163], 0
    v_max3_u32 v121, v156, v157, v158
    v_mfma_f32_16x16x32_bf16 v[40:43], v[116:119], v[176:179], 0
    v_max3_u32 v122, v168, v169, v170
    v_mfma_f32_16x16x32_bf16 v[32:35], v[116:119], v[148:151], v[32:35]
    v_max3_u32 v123, v180, v181, v182
    v_mfma_f32_16x16x32_bf16 v[36:39], v[116:119], v[164:167], v[36:39]
    v_max3_u32 v120, v120, v147, v148
    v_mfma_f32_16x16x32_bf16 v[40:43], v[116:119], v[180:183], v[40:43]
    v_max3_u32 v121, v121, v159, v160
    v_mfma_f32_16x16x32_bf16 v[32:35], v[116:119], v[152:155], v[32:35]
    v_max3_u32 v122, v122, v171, v172
    v_mfma_f32_16x16x32_bf16 v[36:39], v[116:119], v[168:171], v[36:39]
    v_max3_u32 v123, v123, v183, v184
    v_mfma_f32_16x16x32_bf16 v[40:43], v[116:119], v[184:187], v[40:43]
    v_max3_u32 v120, v120, v149, v150
    v_mfma_f32_16x16x32_bf16 v[32:35], v[116:119], v[156:159], v[32:35]
    v_max3_u32 v121, v121, v161, v162
    v_mfma_f32_16x16x32_bf16 v[36:39], v[116:119], v[172:175], v[36:39]
    v_max3_u32 v122, v122, v173, v174
    v_mfma_f32_16x16x32_bf16 v[40:43], v[116:119], v[188:191], v[40:43]
    v_max3_u32 v123, v123, v185, v186
    v_max3_u32 v120, v120, v151, v152
    v_max3_u32 v121, v121, v163, v164
    v_max3_u32 v122, v122, v175, v176
    v_max3_u32 v123, v123, v187, v188
    v_max3_u32 v120, v120, v153, v154
    v_max3_u32 v121, v121, v165, v166
    v_max3_u32 v122, v122, v177, v178
    v_max3_u32 v123, v123, v189, v190
    v_max3_u32 v120, v120, v155, v167
    v_max3_u32 v122, v122, v179, v191
    v_max_u32 v121, v121, v123
    v_max3_u32 v120, v120, v121, v122
    v_cmp_eq_u32 vcc, -1, v120
    s_mov_b32 s76, s77
    v_cmp_ne_u64_e64 s[10:11], s[6:7], v[6:7]
    s_cbranch_vccz .Aspec_8
.Ah1_6:
    v_max3_u32 v120, v144, v145, v146
    v_max_u32 v120, v120, v147
    v_cmp_eq_u32_e64 s[52:53], -1, v120
    v_max3_u32 v121, v148, v149, v150
    v_max_u32 v121, v121, v151
    v_cmp_eq_u32_e64 s[54:55], -1, v121
    v_max3_u32 v122, v152, v153, v154
    v_max_u32 v122, v122, v155
    v_cmp_eq_u32_e64 s[56:57], -1, v122
    v_max3_u32 v123, v156, v157, v158
    v_max_u32 v123, v123, v159
    v_cmp_eq_u32_e64 s[58:59], -1, v123
    v_max3_u32 v120, v160, v161, v162
    v_max_u32 v120, v120, v163
    v_cmp_eq_u32_e64 s[60:61], -1, v120
    v_max3_u32 v121, v164, v165, v166
    v_max_u32 v121, v121, v167
    v_cmp_eq_u32_e64 s[62:63], -1, v121
    v_max3_u32 v122, v168, v169, v170
    v_max_u32 v122, v122, v171
    v_cmp_eq_u32_e64 s[64:65], -1, v122
    v_max3_u32 v123, v172, v173, v174
    v_max_u32 v123, v123, v175
    v_cmp_eq_u32_e64 s[66:67], -1, v123
    v_max3_u32 v120, v176, v177, v178
    v_max_u32 v120, v120, v179
    v_cmp_eq_u32_e64 s[68:69], -1, v120
    v_max3_u32 v121, v180, v181, v182
    v_max_u32 v121, v121, v183
    v_cmp_eq_u32_e64 s[70:71], -1, v121
    v_max3_u32 v122, v184, v185, v186
    v_max_u32 v122, v122, v187
    v_cmp_eq_u32_e64 s[72:73], -1, v122
    v_max3_u32 v123, v188, v189, v190
    v_max_u32 v123, v123, v191
    v_cmp_eq_u32_e64 s[74:75], -1, v123
    s_or_b64 s[40:41], s[52:53], s[54:55]
    s_or_b64 s[40:41], s[40:41], s[56:57]
    s_or_b64 s[40:41], s[40:41], s[58:59]
    s_or_b64 s[40:41], s[40:41], s[60:61]
    s_or_b64 s[40:41], s[40:41], s[62:63]
    s_or_b64 s[40:41], s[40:41], s[64:65]
    s_or_b64 s[40:41], s[40:41], s[66:67]
    s_or_b64 s[40:41], s[40:41], s[68:69]
    s_or_b64 s[40:41], s[40:41], s[70:71]
    s_or_b64 s[40:41], s[40:41], s[72:73]
    s_or_b64 s[40:41], s[40:41], s[74:75]
    s_cbranch_scc0 .Ah1done_7
    s_sub_u32 s77, s77, 1
    s_cbranch_scc1 .Ah1done_7
    s_mov_b64 exec, s[52:53]
    global_load_dwordx4 v[144:147], v21, s[18:19] offset:0 sc1
    s_mov_b64 exec, s[54:55]
    global_load_dwordx4 v[148:151], v21, s[18:19] offset:1024 sc1
    s_mov_b64 exec, s[56:57]
    global_load_dwordx4 v[152:155], v21, s[18:19] offset:2048 sc1
    s_mov_b64 exec, s[58:59]
    global_load_dwordx4 v[156:159], v21, s[18:19] offset:3072 sc1
    s_mov_b64 exec, s[60:61]
    global_load_dwordx4 v[160:163], v22, s[18:19] offset:0 sc1
    s_mov_b64 exec, s[62:63]
    global_load_dwordx4 v[164:167], v22, s[18:19] offset:1024 sc1
    s_mov_b64 exec, s[64:65]
    global_load_dwordx4 v[168:171], v22, s[18:19] offset:2048 sc1
    s_mov_b64 exec, s[66:67]
    global_load_dwordx4 v[172:175], v22, s[18:19] offset:3072 sc1
    s_mov_b64 exec, s[68:69]
    global_load_dwordx4 v[176:179], v23, s[18:19] offset:0 sc1
    s_mov_b64 exec, s[70:71]
    global_load_dwordx4 v[180:183], v23, s[18:19] offset:1024 sc1
    s_mov_b64 exec, s[72:73]
    global_load_dwordx4 v[184:187], v23, s[18:19] offset:2048 sc1
    s_mov_b64 exec, s[74:75]
    global_load_dwordx4 v[188:191], v23, s[18:19] offset:3072 sc1
    s_mov_b64 exec, -1
    s_waitcnt vmcnt(0)
    s_branch .Ah1_6
.Ah1done_7:
    s_mov_b32 s76, s77
    v_cmp_ne_u64_e64 s[10:11], s[6:7], v[6:7]
    v_mfma_f32_16x16x32_bf16 v[32:35], v[116:119], v[144:147], 0
    v_mfma_f32_16x16x32_bf16 v[36:39], v[116:119], v[160:163], 0
    v_mfma_f32_16x16x32_bf16 v[40:43], v[116:119], v[176:179], 0
    v_mfma_f32_16x16x32_bf16 v[32:35], v[116:119], v[148:151], v[32:35]
    v_mfma_f32_16x16x32_bf16 v[36:39], v[116:119], v[164:167], v[36:39]
    v_mfma_f32_16x16x32_bf16 v[40:43], v[116:119], v[180:183], v[40:43]
    v_mfma_f32_16x16x32_bf16 v[32:35], v[116:119], v[152:155], v[32:35]
    v_mfma_f32_16x16x32_bf16 v[36:39], v[116:119], v[168:171], v[36:39]
    v_mfma_f32_16x16x32_bf16 v[40:43], v[116:119], v[184:187], v[40:43]
    v_mfma_f32_16x16x32_bf16 v[32:35], v[116:119], v[156:159], v[32:35]
    v_mfma_f32_16x16x32_bf16 v[36:39], v[116:119], v[172:175], v[36:39]
    v_mfma_f32_16x16x32_bf16 v[40:43], v[116:119], v[188:191], v[40:43]
.Aspec_8:
    s_lshl_b32 s40, s14, 8
    s_lshr_b32 s41, s36, 1
    s_lshl_b32 s41, s41, 7
    s_add_u32 s40, s40, s41
    s_add_u32 s40, s40, 819200
    v_lshl_add_u32 v16, v27, 3, s40
    v_cvt_pk_bf16_f32 v120, v32, v33
    v_cvt_pk_bf16_f32 v121, v34, v35
    ds_write_b64 v17, v[120:121] offset:0
    v_cvt_pk_bf16_f32 v122, v36, v37
    v_cvt_pk_bf16_f32 v123, v38, v39
    ds_write_b64 v17, v[122:123] offset:1280
    v_cvt_pk_bf16_f32 v124, v40, v41
    v_cvt_pk_bf16_f32 v125, v42, v43
    ds_write_b64 v17, v[124:125] offset:2560
    s_waitcnt lgkmcnt(0)
    s_barrier
    ds_read_b128 v[144:147], v19 offset:0
    ds_read_b128 v[148:151], v18 offset:0
    ds_read_b128 v[152:155], v19 offset:16
    ds_read_b128 v[156:159], v18 offset:16
    ds_read_b128 v[160:163], v19 offset:32
    ds_read_b128 v[164:167], v18 offset:32
    ds_read_b128 v[168:171], v19 offset:48
    ds_read_b128 v[172:175], v18 offset:48
    s_waitcnt lgkmcnt(7)
    v_mfma_f32_32x32x16_bf16 v[48:63], v[144:147], v[128:131], 0
    s_waitcnt lgkmcnt(6)
    v_mfma_f32_32x32x16_bf16 v[32:47], v[148:151], v[128:131], 0
    s_waitcnt lgkmcnt(5)
    v_mfma_f32_32x32x16_bf16 v[48:63], v[152:155], v[132:135], v[48:63]
    s_waitcnt lgkmcnt(4)
    v_mfma_f32_32x32x16_bf16 v[32:47], v[156:159], v[132:135], v[32:47]
    s_waitcnt lgkmcnt(3)
    v_mfma_f32_32x32x16_bf16 v[48:63], v[160:163], v[136:139], v[48:63]
    s_waitcnt lgkmcnt(2)
    v_mfma_f32_32x32x16_bf16 v[32:47], v[164:167], v[136:139], v[32:47]
    s_waitcnt lgkmcnt(1)
    v_mfma_f32_32x32x16_bf16 v[48:63], v[168:171], v[140:143], v[48:63]
    s_waitcnt lgkmcnt(0)
    v_mfma_f32_32x32x16_bf16 v[32:47], v[172:175], v[140:143], v[32:47]
    s_lshl_b32 s40, s14, 2
    s_add_u32 s40, s40, s36
    s_mul_i32 s41, s40, 17408
    s_add_u32 s41, s41, 1048576
    v_lshl_add_u32 v21, v1, 4, s41
    v_add_u32 v22, 4096, v21
    v_add_u32 v23, 8192, v21
    v_add_u32 v24, 12288, v21
    s_lshl_b32 s41, s40, 15
    s_lshl_b32 s42, s15, 7
    s_add_u32 s41, s41, s42
    v_lshrrev_b32 v28, 4, v1
    v_lshlrev_b32 v20, 11, v27
    v_lshl_add_u32 v20, v28, 4, v20
    v_add_u32 v20, s41, v20
    v_mov_b32 v15, s8
    v_mov_b32 v12, s4
    v_mov_b32 v13, s5
    v_add_f32 v120, 0x358637bd, v48
    v_rcp_f32 v120, v120
    s_nop 0
    v_mul_f32 v32, v32, v120
    v_mul_f32 v33, v33, v120
    v_cvt_pk_bf16_f32 v56, v32, v33
    v_mul_f32 v34, v34, v120
    v_mul_f32 v35, v35, v120
    v_cvt_pk_bf16_f32 v57, v34, v35
    v_mul_f32 v36, v36, v120
    v_mul_f32 v37, v37, v120
    v_cvt_pk_bf16_f32 v58, v36, v37
    v_mul_f32 v38, v38, v120
    v_mul_f32 v39, v39, v120
    v_cvt_pk_bf16_f32 v59, v38, v39
    v_mul_f32 v40, v40, v120
    v_mul_f32 v41, v41, v120
    v_cvt_pk_bf16_f32 v60, v40, v41
    v_mul_f32 v42, v42, v120
    v_mul_f32 v43, v43, v120
    v_cvt_pk_bf16_f32 v61, v42, v43
    v_mul_f32 v44, v44, v120
    v_mul_f32 v45, v45, v120
    v_cvt_pk_bf16_f32 v62, v44, v45
    v_mul_f32 v46, v46, v120
    v_mul_f32 v47, v47, v120
    v_cvt_pk_bf16_f32 v63, v46, v47
    s_cmp_lg_u64 s[10:11], 0
    s_cbranch_scc1 .Ams_9
    global_store_dwordx4 v14, v[56:59], s[18:19]
    global_store_dwordx4 v14, v[60:63], s[18:19] offset:256
.Amj_10:
    s_mov_b32 s77, 0x10000
    s_mov_b32 s42, 0
    s_waitcnt vmcnt(0)
    s_mov_b64 exec, 1
    s_cmp_lg_u64 s[10:11], 0
    s_cbranch_scc1 .Ams_11
    global_store_dwordx2 v15, v[12:13], s[18:19]
.Amj_12:
    s_mov_b64 exec, -1
    global_load_dwordx2 v[10:11], v16, s[18:19] sc1
    s_barrier
    ds_read_b64_tr_b16 v[64:65], v2 offset:0
    ds_read_b64_tr_b16 v[66:67], v2 offset:512
    ds_read_b64_tr_b16 v[68:69], v3 offset:0
    ds_read_b64_tr_b16 v[70:71], v3 offset:512
    ds_read_b64_tr_b16 v[72:73], v4 offset:0
    ds_read_b64_tr_b16 v[74:75], v4 offset:512
    ds_read_b64_tr_b16 v[76:77], v5 offset:0
    ds_read_b64_tr_b16 v[78:79], v5 offset:512
    ds_read_b64_tr_b16 v[80:81], v2 offset:4096
    ds_read_b64_tr_b16 v[82:83], v2 offset:4608
    ds_read_b64_tr_b16 v[84:85], v3 offset:4096
    ds_read_b64_tr_b16 v[86:87], v3 offset:4608
    ds_read_b64_tr_b16 v[88:89], v4 offset:4096
    ds_read_b64_tr_b16 v[90:91], v4 offset:4608
    ds_read_b64_tr_b16 v[92:93], v5 offset:4096
    ds_read_b64_tr_b16 v[94:95], v5 offset:4608
    s_bitcmp1_b32 s42, 0
    s_cbranch_scc0 .Ap_13
.Ab_14:
    global_load_dwordx4 v[128:131], v21, s[18:19] offset:0 sc1
    s_bitcmp1_b32 s42, 1
    s_cbranch_scc0 .Ap_15
.Ab_16:
    global_load_dwordx4 v[132:135], v21, s[18:19] offset:1024 sc1
    s_bitcmp1_b32 s42, 2
    s_cbranch_scc0 .Ap_17
.Ab_18:
    global_load_dwordx4 v[136:139], v21, s[18:19] offset:2048 sc1
    s_bitcmp1_b32 s42, 3
    s_cbranch_scc0 .Ap_19
.Ab_20:
    global_load_dwordx4 v[140:143], v21, s[18:19] offset:3072 sc1
    s_bitcmp1_b32 s42, 4
    s_cbranch_scc0 .Ap_21
.Ab_22:
    global_load_dwordx4 v[144:147], v22, s[18:19] offset:0 sc1
    s_bitcmp1_b32 s42, 5
    s_cbranch_scc0 .Ap_23
.Ab_24:
    global_load_dwordx4 v[148:151], v22, s[18:19] offset:1024 sc1
    s_bitcmp1_b32 s42, 6
    s_cbranch_scc0 .Ap_25
.Ab_26:
    global_load_dwordx4 v[152:155], v22, s[18:19] offset:2048 sc1
    s_bitcmp1_b32 s42, 7
    s_cbranch_scc0 .Ap_27
.Ab_28:
    global_load_dwordx4 v[156:159], v22, s[18:19] offset:3072 sc1
    s_waitcnt vmcnt(7) lgkmcnt(8)
    v_mfma_f32_16x16x32_bf16 v[32:35], v[64:67], v[128:131], 0
    ds_read_b64_tr_b16 v[96:97], v2 offset:8192
    ds_read_b64_tr_b16 v[98:99], v2 offset:8704
    v_mfma_f32_16x16x32_bf16 v[36:39], v[68:71], v[128:131], 0
    ds_read_b64_tr_b16 v[100:101], v3 offset:8192
    ds_read_b64_tr_b16 v[102:103], v3 offset:8704
    v_mfma_f32_16x16x32_bf16 v[40:43], v[72:75], v[128:131], 0
    ds_read_b64_tr_b16 v[104:105], v4 offset:8192
    ds_read_b64_tr_b16 v[106:107], v4 offset:8704
    v_mfma_f32_16x16x32_bf16 v[44:47], v[76:79], v[128:131], 0
    ds_read_b64_tr_b16 v[108:109], v5 offset:8192
    ds_read_b64_tr_b16 v[110:111], v5 offset:8704
    s_bitcmp1_b32 s42, 8
    s_cbranch_scc0 .Ap_29
.Ab_30:
    global_load_dwordx4 v[160:163], v23, s[18:19] offset:0 sc1
    s_waitcnt vmcnt(7) lgkmcnt(8)
    v_mfma_f32_16x16x32_bf16 v[32:35], v[80:83], v[132:135], v[32:35]
    ds_read_b64_tr_b16 v[112:113], v2 offset:12288
    ds_read_b64_tr_b16 v[114:115], v2 offset:12800
    v_mfma_f32_16x16x32_bf16 v[36:39], v[84:87], v[132:135], v[36:39]
    ds_read_b64_tr_b16 v[116:117], v3 offset:12288
    ds_read_b64_tr_b16 v[118:119], v3 offset:12800
    v_mfma_f32_16x16x32_bf16 v[40:43], v[88:91], v[132:135], v[40:43]
    ds_read_b64_tr_b16 v[120:121], v4 offset:12288
    ds_read_b64_tr_b16 v[122:123], v4 offset:12800
    v_mfma_f32_16x16x32_bf16 v[44:47], v[92:95], v[132:135], v[44:47]
    ds_read_b64_tr_b16 v[124:125], v5 offset:12288
    ds_read_b64_tr_b16 v[126:127], v5 offset:12800
    s_bitcmp1_b32 s42, 9
    s_cbranch_scc0 .Ap_31
.Ab_32:
    global_load_dwordx4 v[164:167], v23, s[18:19] offset:1024 sc1
    s_waitcnt vmcnt(7) lgkmcnt(8)
    v_mfma_f32_16x16x32_bf16 v[32:35], v[96:99], v[136:139], v[32:35]
    ds_read_b64_tr_b16 v[64:65], v2 offset:16384
    ds_read_b64_tr_b16 v[66:67], v2 offset:16896
    v_mfma_f32_16x16x32_bf16 v[36:39], v[100:103], v[136:139], v[36:39]
    ds_read_b64_tr_b16 v[68:69], v3 offset:16384
    ds_read_b64_tr_b16 v[70:71], v3 offset:16896
    v_mfma_f32_16x16x32_bf16 v[40:43], v[104:107], v[136:139], v[40:43]
    ds_read_b64_tr_b16 v[72:73], v4 offset:16384
    ds_read_b64_tr_b16 v[74:75], v4 offset:16896
    v_mfma_f32_16x16x32_bf16 v[44:47], v[108:111], v[136:139], v[44:47]
    ds_read_b64_tr_b16 v[76:77], v5 offset:16384
    ds_read_b64_tr_b16 v[78:79], v5 offset:16896
    s_bitcmp1_b32 s42, 10
    s_cbranch_scc0 .Ap_33
.Ab_34:
    global_load_dwordx4 v[168:171], v23, s[18:19] offset:2048 sc1
    s_waitcnt vmcnt(7) lgkmcnt(8)
    v_mfma_f32_16x16x32_bf16 v[32:35], v[112:115], v[140:143], v[32:35]
    ds_read_b64_tr_b16 v[80:81], v2 offset:20480
    ds_read_b64_tr_b16 v[82:83], v2 offset:20992
    v_mfma_f32_16x16x32_bf16 v[36:39], v[116:119], v[140:143], v[36:39]
    ds_read_b64_tr_b16 v[84:85], v3 offset:20480
    ds_read_b64_tr_b16 v[86:87], v3 offset:20992
    v_mfma_f32_16x16x32_bf16 v[40:43], v[120:123], v[140:143], v[40:43]
    ds_read_b64_tr_b16 v[88:89], v4 offset:20480
    ds_read_b64_tr_b16 v[90:91], v4 offset:20992
    v_mfma_f32_16x16x32_bf16 v[44:47], v[124:127], v[140:143], v[44:47]
    ds_read_b64_tr_b16 v[92:93], v5 offset:20480
    ds_read_b64_tr_b16 v[94:95], v5 offset:20992
    s_bitcmp1_b32 s42, 11
    s_cbranch_scc0 .Ap_35
.Ab_36:
    global_load_dwordx4 v[172:175], v23, s[18:19] offset:3072 sc1
    s_waitcnt vmcnt(7) lgkmcnt(8)
    v_mfma_f32_16x16x32_bf16 v[32:35], v[64:67], v[144:147], v[32:35]
    ds_read_b64_tr_b16 v[96:97], v2 offset:24576
    ds_read_b64_tr_b16 v[98:99], v2 offset:25088
    v_mfma_f32_16x16x32_bf16 v[36:39], v[68:71], v[144:147], v[36:39]
    ds_read_b64_tr_b16 v[100:101], v3 offset:24576
    ds_read_b64_tr_b16 v[102:103], v3 offset:25088
    v_mfma_f32_16x16x32_bf16 v[40:43], v[72:75], v[144:147], v[40:43]
    ds_read_b64_tr_b16 v[104:105], v4 offset:24576
    ds_read_b64_tr_b16 v[106:107], v4 offset:25088
    v_mfma_f32_16x16x32_bf16 v[44:47], v[76:79], v[144:147], v[44:47]
    ds_read_b64_tr_b16 v[108:109], v5 offset:24576
    ds_read_b64_tr_b16 v[110:111], v5 offset:25088
    s_bitcmp1_b32 s42, 12
    s_cbranch_scc0 .Ap_37
.Ab_38:
    global_load_dwordx4 v[176:179], v24, s[18:19] offset:0 sc1
    s_waitcnt vmcnt(7) lgkmcnt(8)
    v_mfma_f32_16x16x32_bf16 v[32:35], v[80:83], v[148:151], v[32:35]
    ds_read_b64_tr_b16 v[112:113], v2 offset:28672
    ds_read_b64_tr_b16 v[114:115], v2 offset:29184
    v_mfma_f32_16x16x32_bf16 v[36:39], v[84:87], v[148:151], v[36:39]
    ds_read_b64_tr_b16 v[116:117], v3 offset:28672
    ds_read_b64_tr_b16 v[118:119], v3 offset:29184
    v_mfma_f32_16x16x32_bf16 v[40:43], v[88:91], v[148:151], v[40:43]
    ds_read_b64_tr_b16 v[120:121], v4 offset:28672
    ds_read_b64_tr_b16 v[122:123], v4 offset:29184
    v_mfma_f32_16x16x32_bf16 v[44:47], v[92:95], v[148:151], v[44:47]
    ds_read_b64_tr_b16 v[124:125], v5 offset:28672
    ds_read_b64_tr_b16 v[126:127], v5 offset:29184
    s_bitcmp1_b32 s42, 13
    s_cbranch_scc0 .Ap_39
.Ab_40:
    global_load_dwordx4 v[180:183], v24, s[18:19] offset:1024 sc1
    s_waitcnt vmcnt(7) lgkmcnt(8)
    v_mfma_f32_16x16x32_bf16 v[32:35], v[96:99], v[152:155], v[32:35]
    ds_read_b64_tr_b16 v[64:65], v2 offset:32768
    ds_read_b64_tr_b16 v[66:67], v2 offset:33280
    v_mfma_f32_16x16x32_bf16 v[36:39], v[100:103], v[152:155], v[36:39]
    ds_read_b64_tr_b16 v[68:69], v3 offset:32768
    ds_read_b64_tr_b16 v[70:71], v3 offset:33280
    v_mfma_f32_16x16x32_bf16 v[40:43], v[104:107], v[152:155], v[40:43]
    ds_read_b64_tr_b16 v[72:73], v4 offset:32768
    ds_read_b64_tr_b16 v[74:75], v4 offset:33280
    v_mfma_f32_16x16x32_bf16 v[44:47], v[108:111], v[152:155], v[44:47]
    ds_read_b64_tr_b16 v[76:77], v5 offset:32768
    ds_read_b64_tr_b16 v[78:79], v5 offset:33280
    s_bitcmp1_b32 s42, 14
    s_cbranch_scc0 .Ap_41
.Ab_42:
    global_load_dwordx4 v[184:187], v24, s[18:19] offset:2048 sc1
    s_waitcnt vmcnt(7) lgkmcnt(8)
    v_mfma_f32_16x16x32_bf16 v[32:35], v[112:115], v[156:159], v[32:35]
    ds_read_b64_tr_b16 v[80:81], v2 offset:36864
    ds_read_b64_tr_b16 v[82:83], v2 offset:37376
    v_mfma_f32_16x16x32_bf16 v[36:39], v[116:119], v[156:159], v[36:39]
    ds_read_b64_tr_b16 v[84:85], v3 offset:36864
    ds_read_b64_tr_b16 v[86:87], v3 offset:37376
    v_mfma_f32_16x16x32_bf16 v[40:43], v[120:123], v[156:159], v[40:43]
    ds_read_b64_tr_b16 v[88:89], v4 offset:36864
    ds_read_b64_tr_b16 v[90:91], v4 offset:37376
    v_mfma_f32_16x16x32_bf16 v[44:47], v[124:127], v[156:159], v[44:47]
    ds_read_b64_tr_b16 v[92:93], v5 offset:36864
    ds_read_b64_tr_b16 v[94:95], v5 offset:37376
    s_bitcmp1_b32 s42, 15
    s_cbranch_scc0 .Ap_43
.Ab_44:
    global_load_dwordx4 v[188:191], v24, s[18:19] offset:3072 sc1
    s_waitcnt vmcnt(7) lgkmcnt(8)
    v_mfma_f32_16x16x32_bf16 v[32:35], v[64:67], v[160:163], v[32:35]
    ds_read_b64_tr_b16 v[96:97], v2 offset:40960
    ds_read_b64_tr_b16 v[98:99], v2 offset:41472
    v_mfma_f32_16x16x32_bf16 v[36:39], v[68:71], v[160:163], v[36:39]
    ds_read_b64_tr_b16 v[100:101], v3 offset:40960
    ds_read_b64_tr_b16 v[102:103], v3 offset:41472
    v_mfma_f32_16x16x32_bf16 v[40:43], v[72:75], v[160:163], v[40:43]
    ds_read_b64_tr_b16 v[104:105], v4 offset:40960
    ds_read_b64_tr_b16 v[106:107], v4 offset:41472
    v_mfma_f32_16x16x32_bf16 v[44:47], v[76:79], v[160:163], v[44:47]
    ds_read_b64_tr_b16 v[108:109], v5 offset:40960
    ds_read_b64_tr_b16 v[110:111], v5 offset:41472
    s_waitcnt vmcnt(6) lgkmcnt(8)
    v_mfma_f32_16x16x32_bf16 v[32:35], v[80:83], v[164:167], v[32:35]
    ds_read_b64_tr_b16 v[112:113], v2 offset:45056
    ds_read_b64_tr_b16 v[114:115], v2 offset:45568
    v_mfma_f32_16x16x32_bf16 v[36:39], v[84:87], v[164:167], v[36:39]
    ds_read_b64_tr_b16 v[116:117], v3 offset:45056
    ds_read_b64_tr_b16 v[118:119], v3 offset:45568
    v_mfma_f32_16x16x32_bf16 v[40:43], v[88:91], v[164:167], v[40:43]
    ds_read_b64_tr_b16 v[120:121], v4 offset:45056
    ds_read_b64_tr_b16 v[122:123], v4 offset:45568
    v_mfma_f32_16x16x32_bf16 v[44:47], v[92:95], v[164:167], v[44:47]
    ds_read_b64_tr_b16 v[124:125], v5 offset:45056
    ds_read_b64_tr_b16 v[126:127], v5 offset:45568
    s_waitcnt vmcnt(5) lgkmcnt(8)
    v_mfma_f32_16x16x32_bf16 v[32:35], v[96:99], v[168:171], v[32:35]
    ds_read_b64_tr_b16 v[64:65], v2 offset:49152
    ds_read_b64_tr_b16 v[66:67], v2 offset:49664
    v_mfma_f32_16x16x32_bf16 v[36:39], v[100:103], v[168:171], v[36:39]
    ds_read_b64_tr_b16 v[68:69], v3 offset:49152
    ds_read_b64_tr_b16 v[70:71], v3 offset:49664
    v_mfma_f32_16x16x32_bf16 v[40:43], v[104:107], v[168:171], v[40:43]
    ds_read_b64_tr_b16 v[72:73], v4 offset:49152
    ds_read_b64_tr_b16 v[74:75], v4 offset:49664
    v_mfma_f32_16x16x32_bf16 v[44:47], v[108:111], v[168:171], v[44:47]
    ds_read_b64_tr_b16 v[76:77], v5 offset:49152
    ds_read_b64_tr_b16 v[78:79], v5 offset:49664
    s_waitcnt vmcnt(4) lgkmcnt(8)
    v_mfma_f32_16x16x32_bf16 v[32:35], v[112:115], v[172:175], v[32:35]
    ds_read_b64_tr_b16 v[80:81], v2 offset:53248
    ds_read_b64_tr_b16 v[82:83], v2 offset:53760
    v_mfma_f32_16x16x32_bf16 v[36:39], v[116:119], v[172:175], v[36:39]
    ds_read_b64_tr_b16 v[84:85], v3 offset:53248
    ds_read_b64_tr_b16 v[86:87], v3 offset:53760
    v_mfma_f32_16x16x32_bf16 v[40:43], v[120:123], v[172:175], v[40:43]
    ds_read_b64_tr_b16 v[88:89], v4 offset:53248
    ds_read_b64_tr_b16 v[90:91], v4 offset:53760
    v_mfma_f32_16x16x32_bf16 v[44:47], v[124:127], v[172:175], v[44:47]
    ds_read_b64_tr_b16 v[92:93], v5 offset:53248
    ds_read_b64_tr_b16 v[94:95], v5 offset:53760
    s_waitcnt vmcnt(3) lgkmcnt(8)
    v_mfma_f32_16x16x32_bf16 v[32:35], v[64:67], v[176:179], v[32:35]
    ds_read_b64_tr_b16 v[96:97], v2 offset:57344
    ds_read_b64_tr_b16 v[98:99], v2 offset:57856
    v_mfma_f32_16x16x32_bf16 v[36:39], v[68:71], v[176:179], v[36:39]
    ds_read_b64_tr_b16 v[100:101], v3 offset:57344
    ds_read_b64_tr_b16 v[102:103], v3 offset:57856
    v_mfma_f32_16x16x32_bf16 v[40:43], v[72:75], v[176:179], v[40:43]
    ds_read_b64_tr_b16 v[104:105], v4 offset:57344
    ds_read_b64_tr_b16 v[106:107], v4 offset:57856
    v_mfma_f32_16x16x32_bf16 v[44:47], v[76:79], v[176:179], v[44:47]
    ds_read_b64_tr_b16 v[108:109], v5 offset:57344
    ds_read_b64_tr_b16 v[110:111], v5 offset:57856
    s_waitcnt vmcnt(2) lgkmcnt(8)
    v_mfma_f32_16x16x32_bf16 v[32:35], v[80:83], v[180:183], v[32:35]
    ds_read_b64_tr_b16 v[112:113], v2 offset:61440
    ds_read_b64_tr_b16 v[114:115], v2 offset:61952
    v_mfma_f32_16x16x32_bf16 v[36:39], v[84:87], v[180:183], v[36:39]
    ds_read_b64_tr_b16 v[116:117], v3 offset:61440
    ds_read_b64_tr_b16 v[118:119], v3 offset:61952
    v_mfma_f32_16x16x32_bf16 v[40:43], v[88:91], v[180:183], v[40:43]
    ds_read_b64_tr_b16 v[120:121], v4 offset:61440
    ds_read_b64_tr_b16 v[122:123], v4 offset:61952
    v_mfma_f32_16x16x32_bf16 v[44:47], v[92:95], v[180:183], v[44:47]
    ds_read_b64_tr_b16 v[124:125], v5 offset:61440
    ds_read_b64_tr_b16 v[126:127], v5 offset:61952
    s_waitcnt vmcnt(1) lgkmcnt(8)
    v_mfma_f32_16x16x32_bf16 v[32:35], v[96:99], v[184:187], v[32:35]
    v_mfma_f32_16x16x32_bf16 v[36:39], v[100:103], v[184:187], v[36:39]
    v_mfma_f32_16x16x32_bf16 v[40:43], v[104:107], v[184:187], v[40:43]
    v_mfma_f32_16x16x32_bf16 v[44:47], v[108:111], v[184:187], v[44:47]
    s_waitcnt vmcnt(0) lgkmcnt(0)
    v_mfma_f32_16x16x32_bf16 v[32:35], v[112:115], v[188:191], v[32:35]
    v_mfma_f32_16x16x32_bf16 v[36:39], v[116:119], v[188:191], v[36:39]
    v_mfma_f32_16x16x32_bf16 v[40:43], v[120:123], v[188:191], v[40:43]
    v_mfma_f32_16x16x32_bf16 v[44:47], v[124:127], v[188:191], v[44:47]
    s_nop 7
    v_cvt_pk_bf16_f32 v120, v32, v33
    v_cvt_pk_bf16_f32 v121, v34, v35
    v_cvt_pk_bf16_f32 v122, v36, v37
    v_cvt_pk_bf16_f32 v123, v38, v39
    v_cndmask_b32_e64 v64, v120, v122, s[78:79]
    v_cndmask_b32_e64 v65, v121, v123, s[78:79]
    v_cndmask_b32_e64 v66, v122, v120, s[78:79]
    v_cndmask_b32_e64 v67, v123, v121, s[78:79]
    global_store_dwordx4 v20, v[64:67], s[12:13] offset:0
    v_cvt_pk_bf16_f32 v120, v40, v41
    v_cvt_pk_bf16_f32 v121, v42, v43
    v_cvt_pk_bf16_f32 v122, v44, v45
    v_cvt_pk_bf16_f32 v123, v46, v47
    v_cndmask_b32_e64 v68, v120, v122, s[78:79]
    v_cndmask_b32_e64 v69, v121, v123, s[78:79]
    v_cndmask_b32_e64 v70, v122, v120, s[78:79]
    v_cndmask_b32_e64 v71, v123, v121, s[78:79]
    global_store_dwordx4 v20, v[68:71], s[12:13] offset:64
    s_endpgm
.Ams_9:
    s_nop 1
    global_store_dwordx4 v14, v[56:59], s[18:19] sc1
    global_store_dwordx4 v14, v[60:63], s[18:19] offset:256 sc1
    s_nop 1
    s_branch .Amj_10
.Ams_11:
    s_nop 1
    global_store_dwordx2 v15, v[12:13], s[18:19] sc1
    s_nop 1
    s_branch .Amj_12
.Ap_13:
    s_waitcnt vmcnt(0)
    v_cmp_eq_u64 vcc, s[4:5], v[10:11]
    s_sub_u32 s77, s77, 1
    s_cselect_b32 s42, -1, vcc_lo
    global_load_dwordx2 v[10:11], v16, s[18:19] sc1
    s_bitcmp1_b32 s42, 0
    s_cbranch_scc1 .Ab_14
    s_branch .Ap_13
.Ap_15:
    s_waitcnt vmcnt(0)
    v_cmp_eq_u64 vcc, s[4:5], v[10:11]
    s_sub_u32 s77, s77, 1
    s_cselect_b32 s42, -1, vcc_lo
    global_load_dwordx2 v[10:11], v16, s[18:19] sc1
    s_bitcmp1_b32 s42, 1
    s_cbranch_scc1 .Ab_16
    s_branch .Ap_15
.Ap_17:
    s_waitcnt vmcnt(0)
    v_cmp_eq_u64 vcc, s[4:5], v[10:11]
    s_sub_u32 s77, s77, 1
    s_cselect_b32 s42, -1, vcc_lo
    global_load_dwordx2 v[10:11], v16, s[18:19] sc1
    s_bitcmp1_b32 s42, 2
    s_cbranch_scc1 .Ab_18
    s_branch .Ap_17
.Ap_19:
    s_waitcnt vmcnt(0)
    v_cmp_eq_u64 vcc, s[4:5], v[10:11]
    s_sub_u32 s77, s77, 1
    s_cselect_b32 s42, -1, vcc_lo
    global_load_dwordx2 v[10:11], v16, s[18:19] sc1
    s_bitcmp1_b32 s42, 3
    s_cbranch_scc1 .Ab_20
    s_branch .Ap_19
.Ap_21:
    s_waitcnt vmcnt(0)
    v_cmp_eq_u64 vcc, s[4:5], v[10:11]
    s_sub_u32 s77, s77, 1
    s_cselect_b32 s42, -1, vcc_lo
    global_load_dwordx2 v[10:11], v16, s[18:19] sc1
    s_bitcmp1_b32 s42, 4
    s_cbranch_scc1 .Ab_22
    s_branch .Ap_21
.Ap_23:
    s_waitcnt vmcnt(0)
    v_cmp_eq_u64 vcc, s[4:5], v[10:11]
    s_sub_u32 s77, s77, 1
    s_cselect_b32 s42, -1, vcc_lo
    global_load_dwordx2 v[10:11], v16, s[18:19] sc1
    s_bitcmp1_b32 s42, 5
    s_cbranch_scc1 .Ab_24
    s_branch .Ap_23
.Ap_25:
    s_waitcnt vmcnt(0)
    v_cmp_eq_u64 vcc, s[4:5], v[10:11]
    s_sub_u32 s77, s77, 1
    s_cselect_b32 s42, -1, vcc_lo
    global_load_dwordx2 v[10:11], v16, s[18:19] sc1
    s_bitcmp1_b32 s42, 6
    s_cbranch_scc1 .Ab_26
    s_branch .Ap_25
.Ap_27:
    s_waitcnt vmcnt(0)
    v_cmp_eq_u64 vcc, s[4:5], v[10:11]
    s_sub_u32 s77, s77, 1
    s_cselect_b32 s42, -1, vcc_lo
    global_load_dwordx2 v[10:11], v16, s[18:19] sc1
    s_bitcmp1_b32 s42, 7
    s_cbranch_scc1 .Ab_28
    s_branch .Ap_27
.Ap_29:
    s_waitcnt vmcnt(0)
    v_cmp_eq_u64 vcc, s[4:5], v[10:11]
    s_sub_u32 s77, s77, 1
    s_cselect_b32 s42, -1, vcc_lo
    global_load_dwordx2 v[10:11], v16, s[18:19] sc1
    s_bitcmp1_b32 s42, 8
    s_cbranch_scc1 .Ab_30
    s_branch .Ap_29
.Ap_31:
    s_waitcnt vmcnt(0)
    v_cmp_eq_u64 vcc, s[4:5], v[10:11]
    s_sub_u32 s77, s77, 1
    s_cselect_b32 s42, -1, vcc_lo
    global_load_dwordx2 v[10:11], v16, s[18:19] sc1
    s_bitcmp1_b32 s42, 9
    s_cbranch_scc1 .Ab_32
    s_branch .Ap_31
.Ap_33:
    s_waitcnt vmcnt(0)
    v_cmp_eq_u64 vcc, s[4:5], v[10:11]
    s_sub_u32 s77, s77, 1
    s_cselect_b32 s42, -1, vcc_lo
    global_load_dwordx2 v[10:11], v16, s[18:19] sc1
    s_bitcmp1_b32 s42, 10
    s_cbranch_scc1 .Ab_34
    s_branch .Ap_33
.Ap_35:
    s_waitcnt vmcnt(0)
    v_cmp_eq_u64 vcc, s[4:5], v[10:11]
    s_sub_u32 s77, s77, 1
    s_cselect_b32 s42, -1, vcc_lo
    global_load_dwordx2 v[10:11], v16, s[18:19] sc1
    s_bitcmp1_b32 s42, 11
    s_cbranch_scc1 .Ab_36
    s_branch .Ap_35
.Ap_37:
    s_waitcnt vmcnt(0)
    v_cmp_eq_u64 vcc, s[4:5], v[10:11]
    s_sub_u32 s77, s77, 1
    s_cselect_b32 s42, -1, vcc_lo
    global_load_dwordx2 v[10:11], v16, s[18:19] sc1
    s_bitcmp1_b32 s42, 12
    s_cbranch_scc1 .Ab_38
    s_branch .Ap_37
.Ap_39:
    s_waitcnt vmcnt(0)
    v_cmp_eq_u64 vcc, s[4:5], v[10:11]
    s_sub_u32 s77, s77, 1
    s_cselect_b32 s42, -1, vcc_lo
    global_load_dwordx2 v[10:11], v16, s[18:19] sc1
    s_bitcmp1_b32 s42, 13
    s_cbranch_scc1 .Ab_40
    s_branch .Ap_39
.Ap_41:
    s_waitcnt vmcnt(0)
    v_cmp_eq_u64 vcc, s[4:5], v[10:11]
    s_sub_u32 s77, s77, 1
    s_cselect_b32 s42, -1, vcc_lo
    global_load_dwordx2 v[10:11], v16, s[18:19] sc1
    s_bitcmp1_b32 s42, 14
    s_cbranch_scc1 .Ab_42
    s_branch .Ap_41
.Ap_43:
    s_waitcnt vmcnt(0)
    v_cmp_eq_u64 vcc, s[4:5], v[10:11]
    s_sub_u32 s77, s77, 1
    s_cselect_b32 s42, -1, vcc_lo
    global_load_dwordx2 v[10:11], v16, s[18:19] sc1
    s_bitcmp1_b32 s42, 15
    s_cbranch_scc1 .Ab_44
    s_branch .Ap_43
.LB:
    s_cmp_ge_u32 s2, 512
    s_cbranch_scc1 .Lexit
    s_sub_u32 s2, s2, 256
    s_load_dwordx16 s[4:19], s[0:1], 32
    s_load_dwordx4 s[20:23], s[0:1], 96
    s_load_dwordx4 s[40:43], s[0:1], 112
    s_load_dwordx2 s[90:91], s[0:1], 8
    s_load_dwordx2 s[92:93], s[0:1], 24
    v_and_b32 v1, 63, v0
    v_lshrrev_b32 v2, 6, v0
    s_getreg_b32 s3, hwreg(HW_REG_XCC_ID, 0, 4)
    s_and_b32 s25, s2, 7
    s_lshr_b32 s26, s2, 3
    v_readfirstlane_b32 s24, v2
    s_lshl_b32 s27, s25, 6
    s_lshl_b32 s28, s26, 1
    s_add_u32 s27, s27, s28
    s_and_b32 s29, s24, 1
    s_lshr_b32 s30, s24, 1
    s_add_u32 s28, s27, s29
    s_lshl_b32 s38, s28, 8
    s_lshl_b32 s39, s30, 7
    s_add_u32 s38, s38, s39
    v_lshl_add_u32 v25, v1, 1, s38
    s_lshl_b32 s38, s28, 1
    v_mov_b32 v26, s38
    v_mov_b32 v2, 0
    v_mov_b32 v3, 0
    v_mov_b32 v4, 0
    v_mov_b32 v5, 0
    v_mov_b32 v6, 0
    v_mov_b32 v7, 0
    s_lshl_b32 s38, s26, 16
    s_lshl_b32 s39, s24, 14
    s_add_u32 s38, s38, s39
    s_lshl_b32 s39, s25, 7
    s_add_u32 s38, s38, s39
    v_lshrrev_b32 v16, 3, v1
    v_bfe_u32 v17, v1, 4, 1
    v_and_b32 v18, 7, v1
    v_xor_b32 v17, v17, v18
    v_lshlrev_b32 v16, 10, v16
    v_lshl_add_u32 v16, v17, 4, v16
    s_lshl_b32 s39, s29, 6
    v_xor_b32 v16, s39, v16
    v_add_u32 v16, s38, v16
    v_xor_b32 v17, 32, v16
    s_lshl_b32 s37, s24, 11
    s_add_u32 s37, s37, 66176
    s_waitcnt lgkmcnt(0)
    global_load_ushort v30, v26, s[18:19]
    global_load_ushort v31, v26, s[20:21]
    global_load_short_d16_hi v2, v25, s[6:7]
    global_load_short_d16_hi v3, v25, s[8:9]
    global_load_short_d16_hi v4, v25, s[10:11]
    global_load_short_d16_hi v5, v25, s[12:13]
    global_load_short_d16_hi v6, v25, s[14:15]
    global_load_short_d16_hi v7, v25, s[16:17]
    s_mov_b32 s44, s4
    s_mov_b32 s45, s5
    s_mov_b32 s46, 2097152
    s_mov_b32 s47, 0x00020000
    s_mov_b32 m0, s37
    s_movk_i32 s38, 0x2000
    buffer_load_dwordx4 v16, s[44:47], 0 offen lds
    s_add_u32 m0, s37, 1024
    s_nop 0
    buffer_load_dwordx4 v17, s[44:47], s38 offen lds
    s_mul_i32 s31, s29, 33024
    s_add_u32 s31, s31, 128
    s_mul_i32 s32, s30, 16512
    s_add_u32 s32, s32, s31
    s_lshl_b32 s33, s30, 13
    s_add_u32 s33, s33, s31
    s_add_u32 s33, s33, 16512
    s_mov_b32 s34, 0x01000100
    s_mov_b32 s35, 0x03020302
    v_and_b32 v35, 15, v1
    v_lshrrev_b32 v36, 4, v1
    v_and_b32 v37, 3, v1
    v_bfe_u32 v38, v1, 2, 2
    v_mul_u32_u24 v33, 288, v35
    v_lshl_add_u32 v33, v36, 4, v33
    v_add_u32 v33, s31, v33
    v_min_u32 v34, 8, v35
    v_mul_u32_u24 v34, 288, v34
    v_lshl_add_u32 v34, v36, 4, v34
    s_add_u32 s38, s31, 13824
    v_add_u32 v34, s38, v34
    v_lshrrev_b32 v39, 5, v1
    v_lshl_add_u32 v18, v39, 2, v37
    v_lshl_add_u32 v18, v18, 3, v38
    v_lshlrev_b32 v18, 7, v18
    v_lshrrev_b32 v19, 1, v38
    v_lshl_add_u32 v19, v37, 1, v19
    v_lshl_add_u32 v18, v19, 4, v18
    v_and_b32 v24, 1, v36
    v_lshl_add_u32 v18, v24, 3, v18
    s_lshl_b32 s38, s24, 5
    v_xor_b32 v18, s38, v18
    v_add_u32 v18, 66176, v18
    v_xor_b32 v19, 16, v18
    s_lshl_b32 s38, s24, 20
    s_lshr_b32 s39, s26, 4
    s_lshl_b32 s39, s39, 19
    s_add_u32 s38, s38, s39
    s_and_b32 s39, s26, 15
    s_lshl_b32 s39, s39, 12
    s_add_u32 s38, s38, s39
    s_lshl_b32 s39, s25, 7
    s_add_u32 s38, s38, s39
    s_add_u32 s38, s38, 1024
    v_lshrrev_b32 v21, 1, v37
    v_lshl_add_u32 v21, v24, 1, v21
    v_lshlrev_b32 v20, 16, v21
    v_lshl_add_u32 v20, v39, 11, v20
    v_lshl_add_u32 v20, v38, 5, v20
    v_and_b32 v21, 1, v1
    v_lshl_add_u32 v20, v21, 4, v20
    v_add_u32 v20, s38, v20
    v_add_u32 v21, 0x40000, v20
    s_lshl_b32 s36, s2, 2
    s_add_u32 s36, s36, s24
    s_lshl_b32 s38, s30, 21
    s_lshr_b32 s39, s26, 4
    s_lshl_b32 s39, s39, 19
    s_add_u32 s38, s38, s39
    s_and_b32 s39, s28, 31
    s_lshl_b32 s39, s39, 11
    s_add_u32 s38, s38, s39
    s_lshl_b32 s39, s25, 7
    s_add_u32 s38, s38, s39
    s_add_u32 s38, s38, 1024
    v_lshrrev_b32 v22, 1, v35
    v_lshlrev_b32 v22, 16, v22
    v_and_b32 v23, 1, v1
    v_lshl_add_u32 v22, v23, 6, v22
    v_lshl_add_u32 v22, v36, 4, v22
    v_add_u32 v22, s38, v22
    v_add_u32 v23, 0x100000, v22
    s_lshl_b32 s3, s3, 27
    v_mov_b32 v27, 0
    v_mov_b32 v32, 0x3f80
    s_cmp_lt_u32 s24, 2
    s_mov_b32 s38, 850944
    s_cmov_b32 s38, 794624
    s_lshl_b32 s39, s25, 10
    s_add_u32 s38, s38, s39
    s_lshl_b32 s39, s24, 9
    s_add_u32 s38, s38, s39
    v_lshl_add_u32 v42, v37, 7, s38
    global_load_dword v40, v42, s[42:43]
    s_waitcnt vmcnt(9)
    v_lshlrev_b32 v30, 16, v30
    s_mov_b32 s48, 0x3fb8aa3b
    v_mul_f32 v28, s48, v30
    v_fma_f32 v29, v30, s48, -v28
    v_fmac_f32 v29, 0x32a57060, v30
    v_exp_f32 v28, v28
    v_mul_f32 v29, 0x3f317218, v29
    v_fmac_f32 v28, v28, v29
    v_cvt_pk_bf16_f32 v28, v28, v28
    v_lshlrev_b32 v30, 16, v28
    v_lshlrev_b32 v31, 16, v31
    v_cmp_eq_u32 vcc, 0, v1
    s_nop 1
    v_cndmask_b32 v31, 0, v31, vcc
    s_waitcnt vmcnt(3)
    s_mov_b32 m0, s32
    s_nop 0
    ds_write_addtid_b32 v32 offset:4608
    v_mul_f32 v53, v30, v3
    v_mul_f32 v52, v30, v2
    v_mul_f32 v57, 0.15915494, v53
    v_mul_f32 v56, s48, v52
    v_mul_f32 v67, 0x41000000, v57
    v_mul_f32 v75, 0x43000000, v57
    v_mul_f32 v66, 0x41000000, v56
    v_fract_f32 v63, v67
    v_mul_f32 v74, 0x43000000, v56
    v_fract_f32 v71, v75
    s_waitcnt vmcnt(0)
    s_barrier
    ds_read_b64_tr_b16 v[8:9], v18 offset:0
    ds_read_b64_tr_b16 v[10:11], v18 offset:512
    ds_read_b64_tr_b16 v[12:13], v19 offset:0
    ds_read_b64_tr_b16 v[14:15], v19 offset:512
    s_waitcnt lgkmcnt(2)
    global_store_dwordx4 v20, v[8:11], s[22:23]
    s_waitcnt lgkmcnt(0)
    global_store_dwordx4 v21, v[12:15], s[22:23]
    v_fract_f32 v79, v57
    v_mul_f32 v54, v30, v4
    v_mul_f32 v55, v30, v5
    v_exp_f32 v62, v66
    global_load_dwordx2 v[28:29], v27, s[40:41]
    v_sin_f32 v64, v63
    v_cos_f32 v65, v63
    v_exp_f32 v70, v74
    v_sin_f32 v72, v71
    v_cos_f32 v73, v71
    v_exp_f32 v78, v56
    v_sin_f32 v80, v79
    v_cos_f32 v81, v79
    v_mul_f32_e64 v58, v7, -v55
    v_mul_f32_e64 v59, v7, -v54
    v_fma_f32 v60, v6, v54, v58
    v_fma_f32 v61, -v6, v55, v59
    v_mul_f32 v68, v62, v65
    v_mul_f32_e64 v69, v62, -v64
    v_mul_f32 v76, v70, v73
    v_mul_f32 v77, v70, v72
    v_mul_f32 v82, v78, v81
    v_mul_f32 v83, v78, v80
    v_cvt_pk_bf16_f32 v84, v60, v61
    v_cvt_pk_bf16_f32 v86, v82, v83
    ds_write_addtid_b32 v84 offset:0
    ds_write_addtid_b32 v86 offset:4896
    v_cvt_pk_bf16_f32 v85, v76, v77
    v_mul_f32_e64 v132, v83, -v83
    ds_write_addtid_b32 v85 offset:6912
    v_mul_f32 v133, v83, v82
    v_mul_f32_e64 v87, v61, -v69
    v_fmac_f32 v132, v82, v82
    v_mul_f32 v88, v61, v68
    v_fmac_f32 v133, v82, v83
    v_fmac_f32 v87, v60, v68
    v_cvt_pk_bf16_f32 v134, v132, v133
    v_fmac_f32 v88, v60, v69
    ds_write_addtid_b32 v134 offset:5184
    v_cvt_pk_bf16_f32 v89, v87, v88
    v_mul_f32_e64 v135, v133, -v83
    ds_write_addtid_b32 v89 offset:288
    v_mul_f32 v136, v133, v82
    v_mul_f32_e64 v90, v88, -v69
    v_fmac_f32 v135, v132, v82
    v_mul_f32 v91, v88, v68
    v_fmac_f32 v136, v132, v83
    v_fmac_f32 v90, v87, v68
    v_cvt_pk_bf16_f32 v137, v135, v136
    v_fmac_f32 v91, v87, v69
    ds_write_addtid_b32 v137 offset:5472
    v_cvt_pk_bf16_f32 v92, v90, v91
    v_mul_f32_e64 v138, v136, -v83
    ds_write_addtid_b32 v92 offset:576
    v_mul_f32 v139, v136, v82
    v_mul_f32_e64 v93, v91, -v69
    v_fmac_f32 v138, v135, v82
    v_mul_f32 v94, v91, v68
    v_fmac_f32 v139, v135, v83
    v_fmac_f32 v93, v90, v68
    v_cvt_pk_bf16_f32 v140, v138, v139
    v_fmac_f32 v94, v90, v69
    ds_write_addtid_b32 v140 offset:5760
    v_cvt_pk_bf16_f32 v95, v93, v94
    v_mul_f32_e64 v141, v139, -v83
    ds_write_addtid_b32 v95 offset:864
    v_mul_f32 v142, v139, v82
    v_mul_f32_e64 v96, v94, -v69
    v_fmac_f32 v141, v138, v82
    v_mul_f32 v97, v94, v68
    v_fmac_f32 v142, v138, v83
    v_fmac_f32 v96, v93, v68
    v_cvt_pk_bf16_f32 v143, v141, v142
    v_fmac_f32 v97, v93, v69
    ds_write_addtid_b32 v143 offset:6048
    v_cvt_pk_bf16_f32 v98, v96, v97
    v_mul_f32_e64 v144, v142, -v83
    ds_write_addtid_b32 v98 offset:1152
    v_mul_f32 v145, v142, v82
    v_mul_f32_e64 v99, v97, -v69
    v_fmac_f32 v144, v141, v82
    v_mul_f32 v100, v97, v68
    v_fmac_f32 v145, v141, v83
    v_fmac_f32 v99, v96, v68
    v_cvt_pk_bf16_f32 v146, v144, v145
    v_fmac_f32 v100, v96, v69
    ds_write_addtid_b32 v146 offset:6336
    v_cvt_pk_bf16_f32 v101, v99, v100
    v_mul_f32_e64 v147, v145, -v83
    ds_write_addtid_b32 v101 offset:1440
    v_mul_f32 v148, v145, v82
    v_mul_f32_e64 v102, v100, -v69
    v_fmac_f32 v147, v144, v82
    v_mul_f32 v103, v100, v68
    v_fmac_f32 v148, v144, v83
    v_fmac_f32 v102, v99, v68
    v_cvt_pk_bf16_f32 v149, v147, v148
    v_fmac_f32 v103, v99, v69
    ds_write_addtid_b32 v149 offset:6624
    v_cvt_pk_bf16_f32 v104, v102, v103
    v_mul_f32_e64 v150, v77, -v77
    ds_write_addtid_b32 v104 offset:1728
    v_mul_f32 v151, v77, v76
    v_mul_f32_e64 v105, v103, -v69
    v_fmac_f32 v150, v76, v76
    v_mul_f32 v106, v103, v68
    v_fmac_f32 v151, v76, v77
    v_fmac_f32 v105, v102, v68
    v_cvt_pk_bf16_f32 v152, v150, v151
    v_fmac_f32 v106, v102, v69
    ds_write_addtid_b32 v152 offset:9216
    s_lshl_b32 s38, s25, 10
    s_lshl_b32 s39, s26, 3
    s_add_u32 s38, s38, s39
    s_lshl_b32 s39, s24, 8
    s_add_u32 s38, s38, s39
    s_add_u32 s38, s38, 786432
    v_mov_b32 v26, s38
    s_add_u32 s8, s38, 81920
    v_add_u32 v25, 8192, v26
    s_mov_b32 s49, 0x40000
    s_waitcnt vmcnt(0)
.Bnonce_45:
    v_readfirstlane_b32 s50, v28
    v_readfirstlane_b32 s51, v29
    s_min_u32 s38, s50, s51
    s_cmp_lg_u32 s38, 0
    s_cbranch_scc1 .Bnonced_46
    s_sub_u32 s49, s49, 1
    s_cbranch_scc1 .Bnonced_46
    s_sleep 2
    global_load_dwordx2 v[28:29], v27, s[40:41] sc1
    s_waitcnt vmcnt(0)
    s_branch .Bnonce_45
.Bnonced_46:
    s_or_b32 s5, s51, s3
    s_mov_b32 s4, s50
    v_mov_b32 v29, s5
    s_mov_b64 exec, 1
    global_store_dwordx2 v25, v[28:29], s[42:43]
    s_mov_b64 exec, -1
    v_cvt_pk_bf16_f32 v107, v105, v106
    v_mul_f32_e64 v153, v151, -v77
    ds_write_addtid_b32 v107 offset:2016
    v_mul_f32 v154, v151, v76
    v_mul_f32_e64 v108, v106, -v69
    v_fmac_f32 v153, v150, v76
    v_mul_f32 v109, v106, v68
    v_fmac_f32 v154, v150, v77
    v_fmac_f32 v108, v105, v68
    v_cvt_pk_bf16_f32 v155, v153, v154
    v_fmac_f32 v109, v105, v69
    ds_write_addtid_b32 v155 offset:10368
    v_cvt_pk_bf16_f32 v110, v108, v109
    v_mul_f32_e64 v156, v154, -v77
    ds_write_addtid_b32 v110 offset:2304
    v_mul_f32 v157, v154, v76
    v_mul_f32_e64 v111, v109, -v69
    v_fmac_f32 v156, v153, v76
    v_mul_f32 v112, v109, v68
    v_fmac_f32 v157, v153, v77
    v_fmac_f32 v111, v108, v68
    v_cvt_pk_bf16_f32 v158, v156, v157
    v_fmac_f32 v112, v108, v69
    ds_write_addtid_b32 v158 offset:11520
    v_cvt_pk_bf16_f32 v113, v111, v112
    v_mul_f32_e64 v159, v157, -v77
    ds_write_addtid_b32 v113 offset:2592
    v_mul_f32 v160, v157, v76
    v_mul_f32_e64 v114, v112, -v69
    v_fmac_f32 v159, v156, v76
    v_mul_f32 v115, v112, v68
    v_fmac_f32 v160, v156, v77
    v_fmac_f32 v114, v111, v68
    v_cvt_pk_bf16_f32 v161, v159, v160
    v_fmac_f32 v115, v111, v69
    ds_write_addtid_b32 v161 offset:12096
    v_cvt_pk_bf16_f32 v116, v114, v115
    v_mul_f32_e64 v162, v160, -v77
    ds_write_addtid_b32 v116 offset:2880
    v_mul_f32 v163, v160, v76
    v_mul_f32_e64 v117, v115, -v69
    v_fmac_f32 v162, v159, v76
    v_mul_f32 v118, v115, v68
    v_fmac_f32 v163, v159, v77
    v_fmac_f32 v117, v114, v68
    v_cvt_pk_bf16_f32 v164, v162, v163
    v_fmac_f32 v118, v114, v69
    ds_write_addtid_b32 v164 offset:12672
    v_cvt_pk_bf16_f32 v119, v117, v118
    v_mul_f32_e64 v165, v163, -v77
    ds_write_addtid_b32 v119 offset:3168
    v_mul_f32 v166, v163, v76
    v_mul_f32_e64 v120, v118, -v69
    v_fmac_f32 v165, v162, v76
    v_mul_f32 v121, v118, v68
    v_fmac_f32 v166, v162, v77
    v_fmac_f32 v120, v117, v68
    v_cvt_pk_bf16_f32 v167, v165, v166
    v_fmac_f32 v121, v117, v69
    ds_write_addtid_b32 v167 offset:13248
    v_cvt_pk_bf16_f32 v122, v120, v121
    v_mul_f32_e64 v168, v166, -v77
    ds_write_addtid_b32 v122 offset:3456
    v_mul_f32 v169, v166, v76
    v_mul_f32_e64 v123, v121, -v69
    v_fmac_f32 v168, v165, v76
    v_mul_f32 v124, v121, v68
    v_fmac_f32 v169, v165, v77
    v_fmac_f32 v123, v120, v68
    v_cvt_pk_bf16_f32 v170, v168, v169
    v_fmac_f32 v124, v120, v69
    ds_write_addtid_b32 v170 offset:13824
    v_cvt_pk_bf16_f32 v125, v123, v124
    v_mul_f32_e64 v171, v169, -v77
    ds_write_addtid_b32 v125 offset:3744
    v_mul_f32 v172, v169, v76
    v_mul_f32_e64 v126, v124, -v69
    v_fmac_f32 v171, v168, v76
    v_mul_f32 v127, v124, v68
    v_fmac_f32 v172, v168, v77
    v_fmac_f32 v126, v123, v68
    v_cvt_pk_bf16_f32 v173, v171, v172
    v_fmac_f32 v127, v123, v69
    ds_write_addtid_b32 v173 offset:14112
    v_cvt_pk_bf16_f32 v128, v126, v127
    v_mul_f32_e64 v174, v172, -v77
    ds_write_addtid_b32 v128 offset:4032
    v_mul_f32 v175, v172, v76
    v_mul_f32_e64 v129, v127, -v69
    v_fmac_f32 v174, v171, v76
    v_mul_f32 v130, v127, v68
    v_fmac_f32 v175, v171, v77
    v_fmac_f32 v129, v126, v68
    v_cvt_pk_bf16_f32 v176, v174, v175
    v_fmac_f32 v130, v126, v69
    ds_write_addtid_b32 v176 offset:14400
    v_cvt_pk_bf16_f32 v131, v129, v130
    v_mul_f32_e64 v177, v175, -v77
    ds_write_addtid_b32 v131 offset:4320
    v_mul_f32 v178, v175, v76
    v_mul_f32_e64 v195, v83, -v77
    v_fmac_f32 v177, v174, v76
    v_mul_f32 v196, v83, v76
    v_fmac_f32 v178, v174, v77
    v_fmac_f32 v195, v82, v76
    v_cvt_pk_bf16_f32 v179, v177, v178
    v_fmac_f32 v196, v82, v77
    ds_write_addtid_b32 v179 offset:14688
    v_cvt_pk_bf16_f32 v197, v195, v196
    v_mul_f32_e64 v180, v178, -v77
    ds_write_addtid_b32 v197 offset:7200
    v_mul_f32 v181, v178, v76
    v_mul_f32_e64 v198, v133, -v77
    v_fmac_f32 v180, v177, v76
    v_mul_f32 v199, v133, v76
    v_fmac_f32 v181, v177, v77
    v_fmac_f32 v198, v132, v76
    v_cvt_pk_bf16_f32 v182, v180, v181
    v_fmac_f32 v199, v132, v77
    ds_write_addtid_b32 v182 offset:14976
    v_cvt_pk_bf16_f32 v200, v198, v199
    v_mul_f32_e64 v183, v181, -v77
    ds_write_addtid_b32 v200 offset:7488
    v_mul_f32 v184, v181, v76
    v_mul_f32_e64 v201, v136, -v77
    v_fmac_f32 v183, v180, v76
    v_mul_f32 v202, v136, v76
    v_fmac_f32 v184, v180, v77
    v_fmac_f32 v201, v135, v76
    v_cvt_pk_bf16_f32 v185, v183, v184
    v_fmac_f32 v202, v135, v77
    ds_write_addtid_b32 v185 offset:15264
    v_cvt_pk_bf16_f32 v203, v201, v202
    v_mul_f32_e64 v186, v184, -v77
    ds_write_addtid_b32 v203 offset:7776
    v_mul_f32 v187, v184, v76
    v_mul_f32_e64 v204, v139, -v77
    v_fmac_f32 v186, v183, v76
    v_mul_f32 v205, v139, v76
    v_fmac_f32 v187, v183, v77
    v_fmac_f32 v204, v138, v76
    v_cvt_pk_bf16_f32 v188, v186, v187
    v_fmac_f32 v205, v138, v77
    ds_write_addtid_b32 v188 offset:15552
    v_cvt_pk_bf16_f32 v206, v204, v205
    v_mul_f32_e64 v189, v187, -v77
    ds_write_addtid_b32 v206 offset:8064
    v_mul_f32 v190, v187, v76
    v_mul_f32_e64 v207, v142, -v77
    v_fmac_f32 v189, v186, v76
    v_mul_f32 v208, v142, v76
    v_fmac_f32 v190, v186, v77
    v_fmac_f32 v207, v141, v76
    v_cvt_pk_bf16_f32 v191, v189, v190
    v_fmac_f32 v208, v141, v77
    ds_write_addtid_b32 v191 offset:15840
    v_cvt_pk_bf16_f32 v209, v207, v208
    v_mul_f32_e64 v192, v190, -v77
    ds_write_addtid_b32 v209 offset:8352
    v_mul_f32 v193, v190, v76
    v_mul_f32_e64 v210, v145, -v77
    v_fmac_f32 v192, v189, v76
    v_mul_f32 v211, v145, v76
    v_fmac_f32 v193, v189, v77
    v_fmac_f32 v210, v144, v76
    v_cvt_pk_bf16_f32 v194, v192, v193
    v_fmac_f32 v211, v144, v77
    ds_write_addtid_b32 v194 offset:16128
    v_cvt_pk_bf16_f32 v212, v210, v211
    v_mul_f32_e64 v228, v139, -v154
    ds_write_addtid_b32 v212 offset:8640
    v_mul_f32 v229, v139, v153
    v_mul_f32_e64 v213, v148, -v77
    v_fmac_f32 v228, v138, v153
    v_mul_f32 v214, v148, v76
    v_fmac_f32 v229, v138, v154
    v_fmac_f32 v213, v147, v76
    v_cvt_pk_bf16_f32 v230, v228, v229
    v_fmac_f32 v214, v147, v77
    ds_write_addtid_b32 v230 offset:10944
    v_cvt_pk_bf16_f32 v215, v213, v214
    v_mul_f32_e64 v231, v145, -v154
    ds_write_addtid_b32 v215 offset:8928
    v_mul_f32 v232, v145, v153
    v_mul_f32_e64 v216, v133, -v151
    v_fmac_f32 v231, v144, v153
    v_mul_f32 v217, v133, v150
    v_fmac_f32 v232, v144, v154
    v_fmac_f32 v216, v132, v150
    v_cvt_pk_bf16_f32 v233, v231, v232
    v_fmac_f32 v217, v132, v151
    ds_write_addtid_b32 v233 offset:11232
    v_cvt_pk_bf16_f32 v218, v216, v217
    v_mul_f32_e64 v234, v139, -v157
    ds_write_addtid_b32 v218 offset:9504
    v_mul_f32 v235, v139, v156
    v_mul_f32_e64 v219, v139, -v151
    v_fmac_f32 v234, v138, v156
    v_mul_f32 v220, v139, v150
    v_fmac_f32 v235, v138, v157
    v_fmac_f32 v219, v138, v150
    v_cvt_pk_bf16_f32 v236, v234, v235
    v_fmac_f32 v220, v138, v151
    ds_write_addtid_b32 v236 offset:11808
    v_cvt_pk_bf16_f32 v221, v219, v220
    v_mul_f32_e64 v237, v139, -v160
    ds_write_addtid_b32 v221 offset:9792
    v_mul_f32 v238, v139, v159
    v_mul_f32_e64 v222, v145, -v151
    v_fmac_f32 v237, v138, v159
    v_mul_f32 v223, v145, v150
    v_fmac_f32 v238, v138, v160
    v_fmac_f32 v222, v144, v150
    v_cvt_pk_bf16_f32 v239, v237, v238
    v_fmac_f32 v223, v144, v151
    ds_write_addtid_b32 v239 offset:12384
    v_cvt_pk_bf16_f32 v224, v222, v223
    v_mul_f32_e64 v240, v139, -v163
    ds_write_addtid_b32 v224 offset:10080
    v_mul_f32 v241, v139, v162
    v_mul_f32_e64 v225, v133, -v154
    v_fmac_f32 v240, v138, v162
    v_mul_f32 v226, v133, v153
    v_fmac_f32 v241, v138, v163
    v_fmac_f32 v225, v132, v153
    v_cvt_pk_bf16_f32 v242, v240, v241
    v_fmac_f32 v226, v132, v154
    ds_write_addtid_b32 v242 offset:12960
    v_cvt_pk_bf16_f32 v227, v225, v226
    v_mul_f32_e64 v243, v139, -v166
    ds_write_addtid_b32 v227 offset:10656
    v_mul_f32 v244, v139, v165
    v_fmac_f32 v243, v138, v165
    v_fmac_f32 v244, v138, v166
    v_cvt_pk_bf16_f32 v245, v243, v244
    ds_write_addtid_b32 v245 offset:13536
    s_lshl_b32 s38, s25, 10
    s_lshr_b32 s39, s26, 3
    s_lshl_b32 s39, s39, 8
    s_add_u32 s38, s38, s39
    s_add_u32 s38, s38, 786432
    v_and_b32 v26, 31, v1
    v_lshl_add_u32 v26, v26, 3, s38
    v_add_u32 v25, 81920, v26
    v_xor_b32 v27, 1, v39
    v_lshl_add_u32 v26, v27, 13, v26
    s_lshl_b32 s38, s27, 12
    s_lshl_b32 s39, s24, 11
    s_add_u32 s38, s38, s39
    s_add_u32 s38, s38, 3670016
    v_lshl_add_u32 v27, v1, 4, s38
    s_lshr_b32 s38, s26, 3
    s_lshl_b32 s38, s38, 20
    s_and_b32 s39, s26, 7
    s_lshl_b32 s39, s39, 16
    s_add_u32 s38, s38, s39
    s_lshl_b32 s39, s25, 7
    s_add_u32 s38, s38, s39
    s_add_u32 s38, s38, 1024
    s_lshl_b32 s39, s30, 19
    s_add_u32 s38, s38, s39
    s_lshl_b32 s39, s29, 15
    s_add_u32 s38, s38, s39
    v_lshrrev_b32 v4, 3, v1
    v_lshlrev_b32 v4, 11, v4
    v_and_b32 v5, 7, v1
    v_lshl_add_u32 v4, v5, 4, v4
    v_add_u32 v4, s38, v4
    v_add_u32 v17, 0x4000, v4
    s_waitcnt lgkmcnt(0)
    s_barrier
    global_load_dwordx2 v[28:29], v26, s[42:43] sc1
    ds_read_b128 v[64:67], v33 offset:0
    ds_read_b128 v[68:71], v33 offset:4608
    ds_read_b128 v[72:75], v33 offset:9216
    ds_read_b128 v[76:79], v34 offset:0
    ds_read_b128 v[80:83], v33 offset:64
    ds_read_b128 v[84:87], v33 offset:4672
    ds_read_b128 v[88:91], v33 offset:9280
    ds_read_b128 v[92:95], v34 offset:64
    ds_read_b128 v[96:99], v33 offset:128
    ds_read_b128 v[100:103], v33 offset:4736
    ds_read_b128 v[104:107], v33 offset:9344
    ds_read_b128 v[108:111], v34 offset:128
    ds_read_b128 v[112:115], v33 offset:192
    ds_read_b128 v[116:119], v33 offset:4800
    ds_read_b128 v[120:123], v33 offset:9408
    ds_read_b128 v[124:127], v34 offset:192
    s_waitcnt lgkmcnt(12)
    v_mfma_f32_16x16x32_bf16 v[40:43], v[68:71], v[64:67], 0
    v_mfma_f32_16x16x32_bf16 v[44:47], v[72:75], v[64:67], 0
    v_mfma_f32_16x16x32_bf16 v[48:51], v[76:79], v[64:67], 0
    ds_read_b128 v[128:131], v33 offset:16512
    ds_read_b128 v[132:135], v33 offset:21120
    ds_read_b128 v[136:139], v33 offset:25728
    ds_read_b128 v[140:143], v34 offset:16512
    s_waitcnt lgkmcnt(12)
    v_mfma_f32_16x16x32_bf16 v[40:43], v[84:87], v[80:83], v[40:43]
    v_mfma_f32_16x16x32_bf16 v[44:47], v[88:91], v[80:83], v[44:47]
    v_mfma_f32_16x16x32_bf16 v[48:51], v[92:95], v[80:83], v[48:51]
    ds_read_b128 v[144:147], v33 offset:16576
    ds_read_b128 v[148:151], v33 offset:21184
    ds_read_b128 v[152:155], v33 offset:25792
    ds_read_b128 v[156:159], v34 offset:16576
    s_waitcnt lgkmcnt(12)
    v_mfma_f32_16x16x32_bf16 v[40:43], v[100:103], v[96:99], v[40:43]
    v_mfma_f32_16x16x32_bf16 v[44:47], v[104:107], v[96:99], v[44:47]
    v_mfma_f32_16x16x32_bf16 v[48:51], v[108:111], v[96:99], v[48:51]
    ds_read_b128 v[160:163], v33 offset:16640
    ds_read_b128 v[164:167], v33 offset:21248
    ds_read_b128 v[168:171], v33 offset:25856
    ds_read_b128 v[172:175], v34 offset:16640
    s_waitcnt lgkmcnt(12)
    v_mfma_f32_16x16x32_bf16 v[40:43], v[116:119], v[112:115], v[40:43]
    v_mfma_f32_16x16x32_bf16 v[44:47], v[120:123], v[112:115], v[44:47]
    v_mfma_f32_16x16x32_bf16 v[48:51], v[124:127], v[112:115], v[48:51]
    ds_read_b128 v[176:179], v33 offset:16704
    ds_read_b128 v[180:183], v33 offset:21312
    ds_read_b128 v[184:187], v33 offset:25920
    ds_read_b128 v[188:191], v34 offset:16704
    s_waitcnt lgkmcnt(12)
    v_mfma_f32_16x16x32_bf16 v[40:43], v[132:135], v[128:131], v[40:43]
    v_mfma_f32_16x16x32_bf16 v[44:47], v[136:139], v[128:131], v[44:47]
    v_mfma_f32_16x16x32_bf16 v[48:51], v[140:143], v[128:131], v[48:51]
    s_waitcnt lgkmcnt(8)
    v_mfma_f32_16x16x32_bf16 v[40:43], v[148:151], v[144:147], v[40:43]
    v_mfma_f32_16x16x32_bf16 v[44:47], v[152:155], v[144:147], v[44:47]
    v_mfma_f32_16x16x32_bf16 v[48:51], v[156:159], v[144:147], v[48:51]
    s_waitcnt lgkmcnt(4)
    v_mfma_f32_16x16x32_bf16 v[40:43], v[164:167], v[160:163], v[40:43]
    v_mfma_f32_16x16x32_bf16 v[44:47], v[168:171], v[160:163], v[44:47]
    v_mfma_f32_16x16x32_bf16 v[48:51], v[172:175], v[160:163], v[48:51]
    s_waitcnt lgkmcnt(0)
    s_barrier
    v_mfma_f32_16x16x32_bf16 v[40:43], v[180:183], v[176:179], v[40:43]
    v_mfma_f32_16x16x32_bf16 v[44:47], v[184:187], v[176:179], v[44:47]
    v_mfma_f32_16x16x32_bf16 v[48:51], v[188:191], v[176:179], v[48:51]
    s_mov_b32 s49, 0x40000
    s_waitcnt vmcnt(0)
    v_cmp_ne_u64_e64 s[6:7], s[4:5], v[28:29]
    s_cmp_lg_u32 s6, 0
    s_cbranch_scc1 .Bflagw_51
.Bflagdone_48:
    s_mov_b64 s[6:7], 0
.Bgo_50:
    global_load_dwordx4 v[8:11], v4, s[22:23] sc1
    global_load_dwordx4 v[12:15], v17, s[22:23] sc1
    v_lshlrev_b32 v53, 8, v39
    v_lshl_add_u32 v53, v35, 4, v53
    v_lshl_add_u32 v53, v24, 3, v53
    v_add_u32 v53, s33, v53
    v_cmp_gt_u32 vcc, 2, v36
    v_lshlrev_b32 v54, 2, v35
    v_lshlrev_b32 v55, 3, v35
    v_cndmask_b32 v54, v54, v55, vcc
    v_lshl_add_u32 v54, v36, 7, v54
    v_add_u32 v54, s33, v54
    v_cndmask_b32 v55, 64, 4, vcc
    v_add_u32 v55, v54, v55
    v_lshlrev_b32 v78, 1, v35
    v_lshl_add_u32 v78, v36, 7, v78
    v_add_u32 v78, s33, v78
    v_mov_b32 v80, 0
    v_mov_b32 v81, 0
    v_mov_b32 v79, s33
    ds_write_b64 v79, v[80:81] offset:1080
    v_add_f32 v40, v40, v31
    v_cvt_pk_bf16_f32 v72, v40, v41
    v_cvt_pk_bf16_f32 v73, v42, v43
    v_cvt_pk_bf16_f32 v74, v44, v45
    v_cvt_pk_bf16_f32 v75, v46, v47
    v_cvt_pk_bf16_f32 v76, v48, v49
    v_cvt_pk_bf16_f32 v77, v50, v51
    ds_write_b32 v54, v74 offset:0
    ds_write_b32 v55, v75 offset:0
    ds_write_b16 v78, v76 offset:512
    ds_write_b16_d16_hi v78, v76 offset:544
    ds_write_b16 v78, v77 offset:576
    ds_write_b16_d16_hi v78, v77 offset:608
    ds_write_b64 v53, v[72:73] offset:1088
    v_lshl_add_u32 v82, v1, 3, s33
    v_lshl_add_u32 v83, v1, 4, s33
    v_lshl_add_u32 v79, v1, 5, s33
    v_lshl_add_u32 v32, v1, 2, s33
    s_waitcnt lgkmcnt(1)
    ds_read_b64 v[84:85], v82 offset:0
    ds_read_u16 v86, v82 offset:8
    ds_read_b32 v87, v32 offset:256
    ds_read_u16 v88, v32 offset:260
    ds_read_b32 v89, v32 offset:512
    ds_read_u16 v90, v32 offset:516
    s_lshl_b32 s38, s30, 11
    v_add_u32 v82, s38, v82
    s_lshl_b32 s38, s30, 13
    s_add_u32 s38, s38, s31
    v_lshl_add_u32 v61, v1, 5, s38
    s_waitcnt lgkmcnt(4)
    v_perm_b32 v92, v84, v84, s34
    v_alignbit_b32 v93, v85, v84, 16
    v_perm_b32 v94, v85, v85, s34
    v_alignbit_b32 v95, v86, v85, 16
    ds_write_b128 v83, v[92:95] offset:1600
    s_waitcnt lgkmcnt(3)
    v_perm_b32 v96, v87, v87, s34
    v_mov_b32 v97, v87
    v_perm_b32 v98, v87, v87, s35
    v_perm_b32 v99, v88, v88, s34
    ds_write_b128 v83, v[96:99] offset:2112
    s_waitcnt lgkmcnt(2)
    v_perm_b32 v100, v89, v89, s34
    v_perm_b32 v101, v89, v89, s34
    v_mov_b32 v102, v89
    v_perm_b32 v103, v89, v89, s35
    v_perm_b32 v104, v89, v89, s35
    v_perm_b32 v105, v89, v89, s35
    v_perm_b32 v106, v90, v90, s34
    v_perm_b32 v107, v90, v90, s34
    ds_write_b128 v79, v[100:103] offset:3136
    ds_write_b128 v79, v[104:107] offset:3152
    v_lshlrev_b32 v52, 5, v37
    v_lshl_add_u32 v52, v38, 3, v52
    v_lshlrev_b32 v55, 6, v36
    v_sub_u32 v52, v52, v55
    s_lshl_b32 s38, s30, 10
    s_add_u32 s38, s38, s31
    s_add_u32 s38, s38, 96
    v_add_u32 v52, s38, v52
    v_lshlrev_b32 v56, 5, v35
    v_lshl_add_u32 v56, v36, 4, v56
    s_lshl_b32 s38, s30, 8
    v_subrev_u32 v56, s38, v56
    s_mul_i32 s38, s29, 4160
    s_add_u32 s38, s38, 66208
    v_add_u32 v57, s38, v56
    s_waitcnt lgkmcnt(0)
    ds_read_b64 v[108:109], v82 offset:1080
    ds_read_b64 v[100:101], v82 offset:1088
    ds_read_b64 v[118:119], v82 offset:1592
    ds_read_b64 v[110:111], v82 offset:1600
    ds_read_b64 v[128:129], v82 offset:2104
    ds_read_b64 v[120:121], v82 offset:2112
    ds_read_b64 v[138:139], v82 offset:2616
    ds_read_b64 v[130:131], v82 offset:2624
    v_cmp_le_i32_e64 s[52:53], 32, v56
    v_cmp_le_i32 vcc, 0x60, v56
    s_mov_b64 s[54:55], vcc
    v_cmp_le_i32 vcc, 0xa0, v56
    s_mov_b64 s[56:57], vcc
    v_cmp_le_i32 vcc, 0xe0, v56
    s_mov_b64 s[58:59], vcc
    v_lshlrev_b32 v58, 3, v36
    v_sub_u32 v58, v35, v58
    s_lshl_b32 s38, s30, 6
    v_add_u32 v58, s38, v58
    v_cmp_le_i32_e64 s[60:61], -16, v58
    v_cmp_le_i32_e64 s[62:63], -12, v58
    s_waitcnt lgkmcnt(6)
    v_alignbit_b32 v102, v100, v109, 16
    v_alignbit_b32 v103, v101, v100, 16
    v_mov_b32 v104, v109
    v_mov_b32 v105, v100
    v_alignbit_b32 v106, v109, v108, 16
    v_alignbit_b32 v107, v100, v109, 16
    ds_write_b128 v61, v[100:103] offset:0
    ds_write_b128 v61, v[104:107] offset:16
    s_waitcnt lgkmcnt(6)
    v_alignbit_b32 v112, v110, v119, 16
    v_alignbit_b32 v113, v111, v110, 16
    v_mov_b32 v114, v119
    v_mov_b32 v115, v110
    v_alignbit_b32 v116, v119, v118, 16
    v_alignbit_b32 v117, v110, v119, 16
    ds_write_b128 v61, v[110:113] offset:2048
    ds_write_b128 v61, v[114:117] offset:2064
    s_waitcnt lgkmcnt(6)
    v_alignbit_b32 v122, v120, v129, 16
    v_alignbit_b32 v123, v121, v120, 16
    v_mov_b32 v124, v129
    v_mov_b32 v125, v120
    v_alignbit_b32 v126, v129, v128, 16
    v_alignbit_b32 v127, v120, v129, 16
    ds_write_b128 v61, v[120:123] offset:4096
    ds_write_b128 v61, v[124:127] offset:4112
    s_waitcnt lgkmcnt(6)
    v_alignbit_b32 v132, v130, v139, 16
    v_alignbit_b32 v133, v131, v130, 16
    v_mov_b32 v134, v139
    v_mov_b32 v135, v130
    v_alignbit_b32 v136, v139, v138, 16
    v_alignbit_b32 v137, v130, v139, 16
    ds_write_b128 v61, v[130:133] offset:6144
    ds_write_b128 v61, v[134:137] offset:6160
    v_and_b32 v59, 1, v1
    v_mul_u32_u24 v59, 4160, v59
    v_lshrrev_b32 v60, 1, v1
    v_lshl_add_u32 v59, v60, 4, v59
    s_lshl_b32 s38, s24, 10
    s_add_u32 s38, s38, 66176
    v_add_u32 v59, s38, v59
    s_lshl_b32 s38, s25, 10
    s_add_u32 s38, s38, 851968
    s_lshl_b32 s39, s30, 9
    s_add_u32 s39, s39, s38
    s_and_b32 s10, s28, 63
    s_lshl_b32 s10, s10, 3
    s_add_u32 s39, s39, s10
    v_mov_b32 v2, s39
    s_lshr_b32 s39, s26, 4
    s_lshl_b32 s39, s39, 9
    s_add_u32 s38, s38, s39
    s_and_b32 s39, s26, 8
    s_add_u32 s38, s38, s39
    s_lshl_b32 s39, s30, 8
    s_add_u32 s38, s38, s39
    v_lshl_add_u32 v6, v35, 4, s38
    s_xor_b32 s10, s50, 2
    v_mov_b32 v28, s10
    v_mov_b32 v29, s51
    s_or_b32 s10, s50, 2
    s_mov_b32 s11, s51
    s_waitcnt vmcnt(0)
    ds_write_b128 v59, v[8:11] offset:0
    ds_write_b128 v59, v[12:15] offset:512
    s_mov_b64 exec, 1
    s_cmp_lg_u64 s[6:7], 0
    s_cbranch_scc1 .Bms_52
    global_store_dwordx2 v2, v[28:29], s[42:43]
    s_branch .Bmj_53
.Bms_52:
    global_store_dwordx2 v2, v[28:29], s[42:43] sc1
.Bmj_53:
    s_mov_b64 exec, -1
    s_waitcnt lgkmcnt(0)
    s_barrier
    ds_read_b64_tr_b16 v[96:97], v52 offset:32
    ds_read_b64_tr_b16 v[98:99], v52 offset:0
    v_mov_b32 v128, 0
    v_mov_b32 v129, 0
    v_mov_b32 v130, 0
    v_mov_b32 v131, 0
    v_subrev_u32 v59, 64, v57
    s_mov_b64 exec, s[52:53]
    ds_read_b128 v[128:131], v59
    s_mov_b64 exec, -1
    ds_read_b64_tr_b16 v[100:101], v52 offset:2080
    ds_read_b64_tr_b16 v[102:103], v52 offset:2048
    ds_read_b128 v[132:135], v57 offset:448
    ds_read_b64_tr_b16 v[104:105], v52 offset:4128
    ds_read_b64_tr_b16 v[106:107], v52 offset:4096
    ds_read_b128 v[136:139], v57 offset:960
    ds_read_b64_tr_b16 v[108:109], v52 offset:6176
    ds_read_b64_tr_b16 v[110:111], v52 offset:6144
    ds_read_b128 v[140:143], v57 offset:1472
    ds_read_b64_tr_b16 v[112:113], v52 offset:8224
    ds_read_b64_tr_b16 v[114:115], v52 offset:8192
    ds_read_b128 v[144:147], v57 offset:1984
    ds_read_b64_tr_b16 v[116:117], v52 offset:10272
    ds_read_b64_tr_b16 v[118:119], v52 offset:10240
    ds_read_b128 v[148:151], v57 offset:2496
    ds_read_b64_tr_b16 v[120:121], v52 offset:12320
    ds_read_b64_tr_b16 v[122:123], v52 offset:12288
    ds_read_b128 v[152:155], v57 offset:3008
    ds_read_b64_tr_b16 v[124:125], v52 offset:14368
    ds_read_b64_tr_b16 v[126:127], v52 offset:14336
    ds_read_b128 v[156:159], v57 offset:3520
    s_xor_b32 s38, s30, 1
    s_lshl_b32 s38, s38, 13
    s_add_u32 s38, s38, s31
    s_add_u32 s38, s38, 16512
    v_lshl_add_u32 v60, v1, 4, s38
    v_mov_b32 v61, v83
    s_waitcnt lgkmcnt(0)
    v_cndmask_b32_e64 v96, 0, v96, s[60:61]
    v_cndmask_b32_e64 v97, 0, v97, s[60:61]
    v_cndmask_b32_e64 v98, 0, v98, s[62:63]
    v_cndmask_b32_e64 v99, 0, v99, s[62:63]
    s_nop 1
    v_mfma_f32_16x16x32_bf16 v[64:67], v[96:99], v[128:131], 0
    ds_read_b64_tr_b16 v[160:161], v52 offset:288
    v_mfma_f32_16x16x32_bf16 v[68:71], v[96:99], v[132:135], 0
    ds_read_b64_tr_b16 v[162:163], v52 offset:256
    v_mfma_f32_16x16x32_bf16 v[72:75], v[96:99], v[136:139], 0
    v_mov_b32 v192, 0
    v_mov_b32 v193, 0
    v_mov_b32 v194, 0
    v_mov_b32 v195, 0
    v_subrev_u32 v59, 0x80, v57
    s_mov_b64 exec, s[54:55]
    ds_read_b128 v[192:195], v59
    s_mov_b64 exec, -1
    v_mfma_f32_16x16x32_bf16 v[76:79], v[96:99], v[140:143], 0
    ds_read_b64_tr_b16 v[164:165], v52 offset:2336
    v_mfma_f32_16x16x32_bf16 v[80:83], v[96:99], v[144:147], 0
    ds_read_b64_tr_b16 v[166:167], v52 offset:2304
    v_mfma_f32_16x16x32_bf16 v[84:87], v[96:99], v[148:151], 0
    ds_read_b128 v[196:199], v57 offset:384
    v_mfma_f32_16x16x32_bf16 v[88:91], v[96:99], v[152:155], 0
    ds_read_b64_tr_b16 v[168:169], v52 offset:4384
    v_mfma_f32_16x16x32_bf16 v[92:95], v[96:99], v[156:159], 0
    ds_read_b64_tr_b16 v[170:171], v52 offset:4352
    v_mfma_f32_16x16x32_bf16 v[68:71], v[100:103], v[128:131], v[68:71]
    ds_read_b128 v[200:203], v57 offset:896
    v_mfma_f32_16x16x32_bf16 v[72:75], v[100:103], v[132:135], v[72:75]
    ds_read_b64_tr_b16 v[172:173], v52 offset:6432
    v_mfma_f32_16x16x32_bf16 v[76:79], v[100:103], v[136:139], v[76:79]
    ds_read_b64_tr_b16 v[174:175], v52 offset:6400
    v_mfma_f32_16x16x32_bf16 v[80:83], v[100:103], v[140:143], v[80:83]
    ds_read_b128 v[204:207], v57 offset:1408
    v_mfma_f32_16x16x32_bf16 v[84:87], v[100:103], v[144:147], v[84:87]
    ds_read_b64_tr_b16 v[176:177], v52 offset:8480
    v_mfma_f32_16x16x32_bf16 v[88:91], v[100:103], v[148:151], v[88:91]
    ds_read_b64_tr_b16 v[178:179], v52 offset:8448
    v_mfma_f32_16x16x32_bf16 v[92:95], v[100:103], v[152:155], v[92:95]
    ds_read_b128 v[208:211], v57 offset:1920
    v_mfma_f32_16x16x32_bf16 v[72:75], v[104:107], v[128:131], v[72:75]
    ds_read_b64_tr_b16 v[180:181], v52 offset:10528
    v_mfma_f32_16x16x32_bf16 v[76:79], v[104:107], v[132:135], v[76:79]
    ds_read_b64_tr_b16 v[182:183], v52 offset:10496
    v_mfma_f32_16x16x32_bf16 v[80:83], v[104:107], v[136:139], v[80:83]
    ds_read_b128 v[212:215], v57 offset:2432
    v_mfma_f32_16x16x32_bf16 v[84:87], v[104:107], v[140:143], v[84:87]
    ds_read_b64_tr_b16 v[184:185], v52 offset:12576
    v_mfma_f32_16x16x32_bf16 v[88:91], v[104:107], v[144:147], v[88:91]
    ds_read_b64_tr_b16 v[186:187], v52 offset:12544
    v_mfma_f32_16x16x32_bf16 v[92:95], v[104:107], v[148:151], v[92:95]
    ds_read_b128 v[216:219], v57 offset:2944
    v_mfma_f32_16x16x32_bf16 v[76:79], v[108:111], v[128:131], v[76:79]
    ds_read_b64_tr_b16 v[188:189], v52 offset:14624
    v_mfma_f32_16x16x32_bf16 v[80:83], v[108:111], v[132:135], v[80:83]
    ds_read_b64_tr_b16 v[190:191], v52 offset:14592
    v_mfma_f32_16x16x32_bf16 v[84:87], v[108:111], v[136:139], v[84:87]
    ds_read_b128 v[220:223], v57 offset:3456
    v_mfma_f32_16x16x32_bf16 v[88:91], v[108:111], v[140:143], v[88:91]
    v_mfma_f32_16x16x32_bf16 v[92:95], v[108:111], v[144:147], v[92:95]
    v_mfma_f32_16x16x32_bf16 v[80:83], v[112:115], v[128:131], v[80:83]
    v_mfma_f32_16x16x32_bf16 v[84:87], v[112:115], v[132:135], v[84:87]
    v_mfma_f32_16x16x32_bf16 v[88:91], v[112:115], v[136:139], v[88:91]
    v_mfma_f32_16x16x32_bf16 v[92:95], v[112:115], v[140:143], v[92:95]
    v_mfma_f32_16x16x32_bf16 v[84:87], v[116:119], v[128:131], v[84:87]
    v_mfma_f32_16x16x32_bf16 v[88:91], v[116:119], v[132:135], v[88:91]
    v_mfma_f32_16x16x32_bf16 v[92:95], v[116:119], v[136:139], v[92:95]
    v_mfma_f32_16x16x32_bf16 v[88:91], v[120:123], v[128:131], v[88:91]
    v_mfma_f32_16x16x32_bf16 v[92:95], v[120:123], v[132:135], v[92:95]
    v_mfma_f32_16x16x32_bf16 v[92:95], v[124:127], v[128:131], v[92:95]
    s_waitcnt lgkmcnt(0)
    v_mfma_f32_16x16x32_bf16 v[64:67], v[160:163], v[192:195], v[64:67]
    ds_read_b64_tr_b16 v[96:97], v52 offset:544
    v_mfma_f32_16x16x32_bf16 v[68:71], v[160:163], v[196:199], v[68:71]
    ds_read_b64_tr_b16 v[98:99], v52 offset:512
    v_mfma_f32_16x16x32_bf16 v[72:75], v[160:163], v[200:203], v[72:75]
    v_mov_b32 v128, 0
    v_mov_b32 v129, 0
    v_mov_b32 v130, 0
    v_mov_b32 v131, 0
    v_subrev_u32 v59, 0xc0, v57
    s_mov_b64 exec, s[56:57]
    ds_read_b128 v[128:131], v59
    s_mov_b64 exec, -1
    v_mfma_f32_16x16x32_bf16 v[76:79], v[160:163], v[204:207], v[76:79]
    ds_read_b64_tr_b16 v[100:101], v52 offset:2592
    v_mfma_f32_16x16x32_bf16 v[80:83], v[160:163], v[208:211], v[80:83]
    ds_read_b64_tr_b16 v[102:103], v52 offset:2560
    v_mfma_f32_16x16x32_bf16 v[84:87], v[160:163], v[212:215], v[84:87]
    ds_read_b128 v[132:135], v57 offset:320
    v_mfma_f32_16x16x32_bf16 v[88:91], v[160:163], v[216:219], v[88:91]
    ds_read_b64_tr_b16 v[104:105], v52 offset:4640
    v_mfma_f32_16x16x32_bf16 v[92:95], v[160:163], v[220:223], v[92:95]
    ds_read_b64_tr_b16 v[106:107], v52 offset:4608
    v_mfma_f32_16x16x32_bf16 v[68:71], v[164:167], v[192:195], v[68:71]
    ds_read_b128 v[136:139], v57 offset:832
    v_mfma_f32_16x16x32_bf16 v[72:75], v[164:167], v[196:199], v[72:75]
    ds_read_b64_tr_b16 v[108:109], v52 offset:6688
    v_mfma_f32_16x16x32_bf16 v[76:79], v[164:167], v[200:203], v[76:79]
    ds_read_b64_tr_b16 v[110:111], v52 offset:6656
    v_mfma_f32_16x16x32_bf16 v[80:83], v[164:167], v[204:207], v[80:83]
    ds_read_b128 v[140:143], v57 offset:1344
    v_mfma_f32_16x16x32_bf16 v[84:87], v[164:167], v[208:211], v[84:87]
    ds_read_b64_tr_b16 v[112:113], v52 offset:8736
    v_mfma_f32_16x16x32_bf16 v[88:91], v[164:167], v[212:215], v[88:91]
    ds_read_b64_tr_b16 v[114:115], v52 offset:8704
    v_mfma_f32_16x16x32_bf16 v[92:95], v[164:167], v[216:219], v[92:95]
    ds_read_b128 v[144:147], v57 offset:1856
    v_mfma_f32_16x16x32_bf16 v[72:75], v[168:171], v[192:195], v[72:75]
    ds_read_b64_tr_b16 v[116:117], v52 offset:10784
    v_mfma_f32_16x16x32_bf16 v[76:79], v[168:171], v[196:199], v[76:79]
    ds_read_b64_tr_b16 v[118:119], v52 offset:10752
    v_mfma_f32_16x16x32_bf16 v[80:83], v[168:171], v[200:203], v[80:83]
    ds_read_b128 v[148:151], v57 offset:2368
    v_mfma_f32_16x16x32_bf16 v[84:87], v[168:171], v[204:207], v[84:87]
    ds_read_b64_tr_b16 v[120:121], v52 offset:12832
    v_mfma_f32_16x16x32_bf16 v[88:91], v[168:171], v[208:211], v[88:91]
    ds_read_b64_tr_b16 v[122:123], v52 offset:12800
    v_mfma_f32_16x16x32_bf16 v[92:95], v[168:171], v[212:215], v[92:95]
    ds_read_b128 v[152:155], v57 offset:2880
    v_mfma_f32_16x16x32_bf16 v[76:79], v[172:175], v[192:195], v[76:79]
    ds_read_b64_tr_b16 v[124:125], v52 offset:14880
    v_mfma_f32_16x16x32_bf16 v[80:83], v[172:175], v[196:199], v[80:83]
    ds_read_b64_tr_b16 v[126:127], v52 offset:14848
    v_mfma_f32_16x16x32_bf16 v[84:87], v[172:175], v[200:203], v[84:87]
    ds_read_b128 v[156:159], v57 offset:3392
    v_mfma_f32_16x16x32_bf16 v[88:91], v[172:175], v[204:207], v[88:91]
    v_mfma_f32_16x16x32_bf16 v[92:95], v[172:175], v[208:211], v[92:95]
    v_mfma_f32_16x16x32_bf16 v[80:83], v[176:179], v[192:195], v[80:83]
    v_mfma_f32_16x16x32_bf16 v[84:87], v[176:179], v[196:199], v[84:87]
    v_mfma_f32_16x16x32_bf16 v[88:91], v[176:179], v[200:203], v[88:91]
    v_mfma_f32_16x16x32_bf16 v[92:95], v[176:179], v[204:207], v[92:95]
    v_mfma_f32_16x16x32_bf16 v[84:87], v[180:183], v[192:195], v[84:87]
    v_mfma_f32_16x16x32_bf16 v[88:91], v[180:183], v[196:199], v[88:91]
    v_mfma_f32_16x16x32_bf16 v[92:95], v[180:183], v[200:203], v[92:95]
    v_mfma_f32_16x16x32_bf16 v[88:91], v[184:187], v[192:195], v[88:91]
    v_mfma_f32_16x16x32_bf16 v[92:95], v[184:187], v[196:199], v[92:95]
    v_mfma_f32_16x16x32_bf16 v[92:95], v[188:191], v[192:195], v[92:95]
    s_waitcnt lgkmcnt(0)
    v_mfma_f32_16x16x32_bf16 v[64:67], v[96:99], v[128:131], v[64:67]
    ds_read_b64_tr_b16 v[160:161], v52 offset:800
    v_mfma_f32_16x16x32_bf16 v[68:71], v[96:99], v[132:135], v[68:71]
    ds_read_b64_tr_b16 v[162:163], v52 offset:768
    v_mfma_f32_16x16x32_bf16 v[72:75], v[96:99], v[136:139], v[72:75]
    v_mov_b32 v192, 0
    v_mov_b32 v193, 0
    v_mov_b32 v194, 0
    v_mov_b32 v195, 0
    v_subrev_u32 v59, 0x100, v57
    s_mov_b64 exec, s[58:59]
    ds_read_b128 v[192:195], v59
    s_mov_b64 exec, -1
    v_mfma_f32_16x16x32_bf16 v[76:79], v[96:99], v[140:143], v[76:79]
    ds_read_b64_tr_b16 v[164:165], v52 offset:2848
    v_mfma_f32_16x16x32_bf16 v[80:83], v[96:99], v[144:147], v[80:83]
    ds_read_b64_tr_b16 v[166:167], v52 offset:2816
    v_mfma_f32_16x16x32_bf16 v[84:87], v[96:99], v[148:151], v[84:87]
    ds_read_b128 v[196:199], v57 offset:256
    v_mfma_f32_16x16x32_bf16 v[88:91], v[96:99], v[152:155], v[88:91]
    ds_read_b64_tr_b16 v[168:169], v52 offset:4896
    v_mfma_f32_16x16x32_bf16 v[92:95], v[96:99], v[156:159], v[92:95]
    ds_read_b64_tr_b16 v[170:171], v52 offset:4864
    v_mfma_f32_16x16x32_bf16 v[68:71], v[100:103], v[128:131], v[68:71]
    ds_read_b128 v[200:203], v57 offset:768
    v_mfma_f32_16x16x32_bf16 v[72:75], v[100:103], v[132:135], v[72:75]
    ds_read_b64_tr_b16 v[172:173], v52 offset:6944
    v_mfma_f32_16x16x32_bf16 v[76:79], v[100:103], v[136:139], v[76:79]
    ds_read_b64_tr_b16 v[174:175], v52 offset:6912
    v_mfma_f32_16x16x32_bf16 v[80:83], v[100:103], v[140:143], v[80:83]
    ds_read_b128 v[204:207], v57 offset:1280
    v_mfma_f32_16x16x32_bf16 v[84:87], v[100:103], v[144:147], v[84:87]
    ds_read_b64_tr_b16 v[176:177], v52 offset:8992
    v_mfma_f32_16x16x32_bf16 v[88:91], v[100:103], v[148:151], v[88:91]
    ds_read_b64_tr_b16 v[178:179], v52 offset:8960
    v_mfma_f32_16x16x32_bf16 v[92:95], v[100:103], v[152:155], v[92:95]
    ds_read_b128 v[208:211], v57 offset:1792
    v_mfma_f32_16x16x32_bf16 v[72:75], v[104:107], v[128:131], v[72:75]
    ds_read_b64_tr_b16 v[180:181], v52 offset:11040
    v_mfma_f32_16x16x32_bf16 v[76:79], v[104:107], v[132:135], v[76:79]
    ds_read_b64_tr_b16 v[182:183], v52 offset:11008
    v_mfma_f32_16x16x32_bf16 v[80:83], v[104:107], v[136:139], v[80:83]
    ds_read_b128 v[212:215], v57 offset:2304
    v_mfma_f32_16x16x32_bf16 v[84:87], v[104:107], v[140:143], v[84:87]
    ds_read_b64_tr_b16 v[184:185], v52 offset:13088
    v_mfma_f32_16x16x32_bf16 v[88:91], v[104:107], v[144:147], v[88:91]
    ds_read_b64_tr_b16 v[186:187], v52 offset:13056
    v_mfma_f32_16x16x32_bf16 v[92:95], v[104:107], v[148:151], v[92:95]
    ds_read_b128 v[216:219], v57 offset:2816
    v_mfma_f32_16x16x32_bf16 v[76:79], v[108:111], v[128:131], v[76:79]
    ds_read_b64_tr_b16 v[188:189], v52 offset:15136
    v_mfma_f32_16x16x32_bf16 v[80:83], v[108:111], v[132:135], v[80:83]
    ds_read_b64_tr_b16 v[190:191], v52 offset:15104
    v_mfma_f32_16x16x32_bf16 v[84:87], v[108:111], v[136:139], v[84:87]
    ds_read_b128 v[220:223], v57 offset:3328
    v_mfma_f32_16x16x32_bf16 v[88:91], v[108:111], v[140:143], v[88:91]
    v_mfma_f32_16x16x32_bf16 v[92:95], v[108:111], v[144:147], v[92:95]
    v_mfma_f32_16x16x32_bf16 v[80:83], v[112:115], v[128:131], v[80:83]
    v_mfma_f32_16x16x32_bf16 v[84:87], v[112:115], v[132:135], v[84:87]
    v_mfma_f32_16x16x32_bf16 v[88:91], v[112:115], v[136:139], v[88:91]
    v_mfma_f32_16x16x32_bf16 v[92:95], v[112:115], v[140:143], v[92:95]
    v_mfma_f32_16x16x32_bf16 v[84:87], v[116:119], v[128:131], v[84:87]
    v_mfma_f32_16x16x32_bf16 v[88:91], v[116:119], v[132:135], v[88:91]
    v_mfma_f32_16x16x32_bf16 v[92:95], v[116:119], v[136:139], v[92:95]
    v_mfma_f32_16x16x32_bf16 v[88:91], v[120:123], v[128:131], v[88:91]
    v_mfma_f32_16x16x32_bf16 v[92:95], v[120:123], v[132:135], v[92:95]
    v_mfma_f32_16x16x32_bf16 v[92:95], v[124:127], v[128:131], v[92:95]
    s_waitcnt lgkmcnt(0)
    global_load_dwordx2 v[18:19], v6, s[42:43] sc1
    v_mfma_f32_16x16x32_bf16 v[64:67], v[160:163], v[192:195], v[64:67]
    v_mfma_f32_16x16x32_bf16 v[68:71], v[160:163], v[196:199], v[68:71]
    v_mfma_f32_16x16x32_bf16 v[72:75], v[160:163], v[200:203], v[72:75]
    v_mfma_f32_16x16x32_bf16 v[76:79], v[160:163], v[204:207], v[76:79]
    v_mfma_f32_16x16x32_bf16 v[80:83], v[160:163], v[208:211], v[80:83]
    v_mfma_f32_16x16x32_bf16 v[84:87], v[160:163], v[212:215], v[84:87]
    v_mfma_f32_16x16x32_bf16 v[88:91], v[160:163], v[216:219], v[88:91]
    v_mfma_f32_16x16x32_bf16 v[92:95], v[160:163], v[220:223], v[92:95]
    v_mfma_f32_16x16x32_bf16 v[68:71], v[164:167], v[192:195], v[68:71]
    v_mfma_f32_16x16x32_bf16 v[72:75], v[164:167], v[196:199], v[72:75]
    v_mfma_f32_16x16x32_bf16 v[76:79], v[164:167], v[200:203], v[76:79]
    v_mfma_f32_16x16x32_bf16 v[80:83], v[164:167], v[204:207], v[80:83]
    v_mfma_f32_16x16x32_bf16 v[84:87], v[164:167], v[208:211], v[84:87]
    v_mfma_f32_16x16x32_bf16 v[88:91], v[164:167], v[212:215], v[88:91]
    v_mfma_f32_16x16x32_bf16 v[92:95], v[164:167], v[216:219], v[92:95]
    v_mfma_f32_16x16x32_bf16 v[72:75], v[168:171], v[192:195], v[72:75]
    v_mfma_f32_16x16x32_bf16 v[76:79], v[168:171], v[196:199], v[76:79]
    v_mfma_f32_16x16x32_bf16 v[80:83], v[168:171], v[200:203], v[80:83]
    v_mfma_f32_16x16x32_bf16 v[84:87], v[168:171], v[204:207], v[84:87]
    v_mfma_f32_16x16x32_bf16 v[88:91], v[168:171], v[208:211], v[88:91]
    v_mfma_f32_16x16x32_bf16 v[92:95], v[168:171], v[212:215], v[92:95]
    v_mfma_f32_16x16x32_bf16 v[76:79], v[172:175], v[192:195], v[76:79]
    v_mfma_f32_16x16x32_bf16 v[80:83], v[172:175], v[196:199], v[80:83]
    v_mfma_f32_16x16x32_bf16 v[84:87], v[172:175], v[200:203], v[84:87]
    v_mfma_f32_16x16x32_bf16 v[88:91], v[172:175], v[204:207], v[88:91]
    v_mfma_f32_16x16x32_bf16 v[92:95], v[172:175], v[208:211], v[92:95]
    v_mfma_f32_16x16x32_bf16 v[80:83], v[176:179], v[192:195], v[80:83]
    v_mfma_f32_16x16x32_bf16 v[84:87], v[176:179], v[196:199], v[84:87]
    v_mfma_f32_16x16x32_bf16 v[88:91], v[176:179], v[200:203], v[88:91]
    v_mfma_f32_16x16x32_bf16 v[92:95], v[176:179], v[204:207], v[92:95]
    v_mfma_f32_16x16x32_bf16 v[84:87], v[180:183], v[192:195], v[84:87]
    v_mfma_f32_16x16x32_bf16 v[88:91], v[180:183], v[196:199], v[88:91]
    v_mfma_f32_16x16x32_bf16 v[92:95], v[180:183], v[200:203], v[92:95]
    v_mfma_f32_16x16x32_bf16 v[88:91], v[184:187], v[192:195], v[88:91]
    v_mfma_f32_16x16x32_bf16 v[92:95], v[184:187], v[196:199], v[92:95]
    v_mfma_f32_16x16x32_bf16 v[92:95], v[188:191], v[192:195], v[92:95]
    s_cmp_lg_u32 s30, 0
    s_cbranch_scc1 .Bh1_54
    s_nop 7
    ds_write_b128 v61, v[80:83] offset:0
    ds_write_b128 v61, v[84:87] offset:1024
    ds_write_b128 v61, v[88:91] offset:2048
    ds_write_b128 v61, v[92:95] offset:3072
    s_waitcnt lgkmcnt(0)
    s_barrier
    ds_read_b128 v[96:99], v60 offset:0
    ds_read_b128 v[100:103], v60 offset:1024
    ds_read_b128 v[104:107], v60 offset:2048
    ds_read_b128 v[108:111], v60 offset:3072
    s_waitcnt lgkmcnt(3)
    v_add_f32 v96, v96, v64
    v_add_f32 v97, v97, v65
    v_add_f32 v98, v98, v66
    v_add_f32 v99, v99, v67
    v_cvt_pk_bf16_f32 v112, v96, v97
    v_cvt_pk_bf16_f32 v113, v98, v99
    s_waitcnt lgkmcnt(2)
    v_add_f32 v100, v100, v68
    v_add_f32 v101, v101, v69
    v_add_f32 v102, v102, v70
    v_add_f32 v103, v103, v71
    v_cvt_pk_bf16_f32 v114, v100, v101
    v_cvt_pk_bf16_f32 v115, v102, v103
    s_waitcnt lgkmcnt(1)
    v_add_f32 v104, v104, v72
    v_add_f32 v105, v105, v73
    v_add_f32 v106, v106, v74
    v_add_f32 v107, v107, v75
    v_cvt_pk_bf16_f32 v116, v104, v105
    v_cvt_pk_bf16_f32 v117, v106, v107
    s_waitcnt lgkmcnt(0)
    v_add_f32 v108, v108, v76
    v_add_f32 v109, v109, v77
    v_add_f32 v110, v110, v78
    v_add_f32 v111, v111, v79
    v_cvt_pk_bf16_f32 v118, v108, v109
    v_cvt_pk_bf16_f32 v119, v110, v111
    s_branch .Bj_55
.Bh1_54:
    s_nop 7
    ds_write_b128 v61, v[64:67] offset:0
    ds_write_b128 v61, v[68:71] offset:1024
    ds_write_b128 v61, v[72:75] offset:2048
    ds_write_b128 v61, v[76:79] offset:3072
    s_waitcnt lgkmcnt(0)
    s_barrier
    ds_read_b128 v[96:99], v60 offset:0
    ds_read_b128 v[100:103], v60 offset:1024
    ds_read_b128 v[104:107], v60 offset:2048
    ds_read_b128 v[108:111], v60 offset:3072
    s_waitcnt lgkmcnt(3)
    v_add_f32 v96, v96, v80
    v_add_f32 v97, v97, v81
    v_add_f32 v98, v98, v82
    v_add_f32 v99, v99, v83
    v_cvt_pk_bf16_f32 v112, v96, v97
    v_cvt_pk_bf16_f32 v113, v98, v99
    s_waitcnt lgkmcnt(2)
    v_add_f32 v100, v100, v84
    v_add_f32 v101, v101, v85
    v_add_f32 v102, v102, v86
    v_add_f32 v103, v103, v87
    v_cvt_pk_bf16_f32 v114, v100, v101
    v_cvt_pk_bf16_f32 v115, v102, v103
    s_waitcnt lgkmcnt(1)
    v_add_f32 v104, v104, v88
    v_add_f32 v105, v105, v89
    v_add_f32 v106, v106, v90
    v_add_f32 v107, v107, v91
    v_cvt_pk_bf16_f32 v116, v104, v105
    v_cvt_pk_bf16_f32 v117, v106, v107
    s_waitcnt lgkmcnt(0)
    v_add_f32 v108, v108, v92
    v_add_f32 v109, v109, v93
    v_add_f32 v110, v110, v94
    v_add_f32 v111, v111, v95
    v_cvt_pk_bf16_f32 v118, v108, v109
    v_cvt_pk_bf16_f32 v119, v110, v111
.Bj_55:
    s_mov_b32 s49, 0x40000
.Bul_56:
    s_waitcnt vmcnt(0)
    v_or_b32 v18, 2, v18
    v_cmp_ne_u64 vcc, s[10:11], v[18:19]
    s_cbranch_vccz .Buld_57
    s_sub_u32 s49, s49, 1
    s_cbranch_scc1 .Buld_57
    s_sleep 1
    global_load_dwordx2 v[18:19], v6, s[42:43] sc1
    s_branch .Bul_56
.Buld_57:
    s_cmp_lg_u64 s[6:7], 0
    s_cbranch_scc1 .Bms_58
    global_store_dwordx4 v22, v[112:115], s[22:23]
    global_store_dwordx4 v23, v[116:119], s[22:23]
    s_branch .Bmj_59
.Bms_58:
    global_store_dwordx4 v22, v[112:115], s[22:23] sc1
    global_store_dwordx4 v23, v[116:119], s[22:23] sc1
.Bmj_59:
    s_lshl_b32 s38, s25, 10
    s_add_u32 s38, s38, 851968
    s_lshl_b32 s39, s30, 9
    s_add_u32 s39, s39, s38
    s_and_b32 s52, s28, 63
    s_lshl_b32 s52, s52, 3
    s_add_u32 s39, s39, s52
    v_mov_b32 v2, s39
    s_lshr_b32 s39, s26, 4
    s_lshl_b32 s39, s39, 9
    s_add_u32 s39, s39, s38
    s_lshl_b32 s52, s24, 7
    s_add_u32 s39, s39, s52
    v_lshl_add_u32 v3, v35, 3, s39
    v_mov_b32 v28, s50
    v_mov_b32 v29, s51
    s_lshr_b32 s38, s26, 3
    s_lshl_b32 s38, s38, 20
    s_and_b32 s39, s26, 7
    s_lshl_b32 s39, s39, 16
    s_add_u32 s38, s38, s39
    s_lshl_b32 s39, s25, 7
    s_add_u32 s38, s38, s39
    s_add_u32 s53, s38, 1024
    s_add_u32 s52, s33, 4096
    v_lshrrev_b32 v5, 3, v1
    v_mul_u32_u24 v5, 144, v5
    v_and_b32 v6, 7, v1
    v_lshl_add_u32 v5, v6, 4, v5
    v_add_u32 v5, s52, v5
    v_lshl_add_u32 v6, v24, 3, v38
    v_mul_u32_u24 v6, 144, v6
    v_lshl_add_u32 v7, v39, 2, v37
    v_lshl_add_u32 v6, v7, 3, v6
    v_add_u32 v6, s52, v6
    s_lshl_b32 s39, s24, 5
    s_add_u32 s38, s53, s39
    v_and_b32 v7, 1, v38
    v_lshlrev_b32 v7, 8, v7
    v_lshl_add_u32 v7, v39, 3, v7
    v_lshrrev_b32 v16, 1, v38
    v_lshl_add_u32 v7, v16, 2, v7
    v_add_u32 v7, v7, v37
    v_lshlrev_b32 v7, 11, v7
    v_lshl_add_u32 v7, v24, 4, v7
    v_add_u32 v7, s38, v7
    v_add_u32 v16, 0x8000, v7
    s_waitcnt vmcnt(0)
    s_mov_b64 exec, 1
    s_cmp_lg_u64 s[6:7], 0
    s_cbranch_scc1 .Bms_60
    global_store_dwordx2 v2, v[28:29], s[42:43]
    s_branch .Bmj_61
.Bms_60:
    global_store_dwordx2 v2, v[28:29], s[42:43] sc1
.Bmj_61:
    s_mov_b64 exec, -1
    s_mov_b32 s49, 0x40000
.By_62:
    global_load_dwordx2 v[18:19], v3, s[42:43] sc1
    s_waitcnt vmcnt(0)
    v_cmp_ne_u64 vcc, s[50:51], v[18:19]
    s_cbranch_vccz .Bydone_63
    s_sub_u32 s49, s49, 1
    s_cbranch_scc1 .Bydone_63
    s_sleep 1
    s_branch .By_62
.Bydone_63:
    global_load_dwordx4 v[8:11], v4, s[22:23] sc1
    global_load_dwordx4 v[12:15], v17, s[22:23] sc1
    s_waitcnt vmcnt(1)
    ds_write_b128 v5, v[8:11] offset:0
    s_waitcnt vmcnt(0)
    ds_write_b128 v5, v[12:15] offset:1152
    s_waitcnt lgkmcnt(0)
    ds_read_b64_tr_b16 v[96:97], v6 offset:0
    ds_read_b64_tr_b16 v[98:99], v6 offset:576
    ds_read_b64_tr_b16 v[100:101], v6 offset:64
    ds_read_b64_tr_b16 v[102:103], v6 offset:640
    s_barrier
    s_waitcnt lgkmcnt(2)
    global_store_dwordx4 v7, v[96:99], s[22:23]
    s_waitcnt lgkmcnt(0)
    global_store_dwordx4 v16, v[100:103], s[22:23]
    s_endpgm
.Bflag_47:
    s_waitcnt vmcnt(0)
    v_cmp_ne_u64_e64 s[6:7], s[4:5], v[28:29]
    s_cmp_eq_u32 s6, 0
    s_cbranch_scc1 .Bflagdone_48
.Bflagw_51:
    v_and_b32 v29, 0x87ffffff, v29
    v_cmp_ne_u64 vcc, s[50:51], v[28:29]
    s_cmp_eq_u32 vcc_hi, 0
    s_cbranch_scc1 .Bslow_49
    s_sub_u32 s49, s49, 1
    s_cbranch_scc1 .Bflagdone_48
    s_cmp_lg_u32 s49, 262136
    s_cbranch_scc1 .Bnos_64
    s_sub_u32 s38, s8, 81920
    v_mov_b32 v30, s38
    v_mov_b32 v28, s4
    v_mov_b32 v29, s5
    s_mov_b64 exec, 1
    global_store_dwordx2 v30, v[28:29], s[42:43] sc1
    s_mov_b64 exec, -1
    s_waitcnt vmcnt(0)
.Bnos_64:
    s_sleep 2
    global_load_dwordx2 v[28:29], v26, s[42:43] sc1
    s_branch .Bflag_47
.Bslow_49:
    s_cmp_eq_u32 s7, 0
    s_cbranch_scc1 .Bflagdone_48
    s_sub_u32 s38, s8, 81920
    v_mov_b32 v30, s38
    v_mov_b32 v28, s4
    v_mov_b32 v29, s5
    s_mov_b64 exec, 1
    global_store_dwordx2 v30, v[28:29], s[42:43] sc1
    s_mov_b64 exec, -1
    s_waitcnt vmcnt(0)
    buffer_wbl2 sc1
    s_waitcnt vmcnt(0)
    v_mov_b32 v26, s8
    v_mov_b32 v29, s51
    s_mov_b64 exec, 1
    global_store_dwordx2 v26, v[28:29], s[42:43] sc1
    s_mov_b64 exec, -1
    s_mov_b64 s[6:7], -1
.Bflag2_65:
    s_nop 1
    global_load_dwordx2 v[28:29], v25, s[42:43] sc1
    s_waitcnt vmcnt(0)
    v_cmp_ne_u64 vcc, s[50:51], v[28:29]
    s_cbranch_vccz .Bgo_50
    s_sub_u32 s49, s49, 1
    s_cbranch_scc1 .Bgo_50
    s_sleep 2
    s_branch .Bflag2_65
.Lexit:
    s_endpgm
.section .rodata,"a"
.p2align 6
.amdhsa_kernel concat_heads__linear_kernel_hedgehog__ssm_conv_s4__prompt_kernel
  .amdhsa_next_free_vgpr 256
  .amdhsa_next_free_sgpr 102
  .amdhsa_accum_offset 256
  .amdhsa_group_segment_fixed_size 0
  .amdhsa_kernarg_size 128
  .amdhsa_user_sgpr_count 2
  .amdhsa_user_sgpr_kernarg_segment_ptr 1
  .amdhsa_system_sgpr_workgroup_id_x 1
.end_amdhsa_kernel
```
